```python
import torch

def _softmax(x, axis=-1):
    return torch.softmax(x, dim=axis)
def _gelu(x):
    return torch.nn.functional.gelu(x, approximate="tanh")
def _silu(x):
    return torch.nn.functional.silu(x)
def _sigmoid(x):
    return torch.sigmoid(x)
def _layernorm(x, axis=-1, eps=1e-5):
    m = x.mean(dim=axis, keepdim=True)
    v = x.var(dim=axis, keepdim=True, unbiased=False)
    return (x - m) / torch.sqrt(v + eps)
def _scatter_add(tgt, idx, src, axis=0):
    return tgt.clone().index_add_(axis, idx, src)
def _segment_sum(src, seg, n):
    out = torch.zeros((n,) + src.shape[1:], dtype=src.dtype)
    return out.index_add_(0, seg, src)
def _pad(x, pw):
    flat = tuple(v for pair in reversed(pw) for v in pair)
    return torch.nn.functional.pad(x, flat)

kernel_name = 'standalone__weight_only_int_gptq__prompt'

def setup_inputs():

    _w = (lambda a: (lambda t: t.to(torch.bfloat16) if t.is_floating_point() else t)(torch.as_tensor(a)))
    B, S, D, F = 1, 2048, 576, 4608
    bits = max(2, min(4, 4))
    pf = 32 // bits
    G = -1 if -1 > 0 else D
    G = max(pf, (G // pf) * pf)
    D = max(G, (D // G) * G)
    ng = D // G
    qmax = 1 << bits
    qw = torch.randint(0, qmax, (D, F)).to(torch.int64)
    packed = torch.zeros((D // pf, F), dtype=torch.int64)
    for i in range(pf):
        packed |= (qw[i::pf] << (i * bits))
    packed = packed.to(torch.int32)
    return {
        "x": _w((lambda *s: torch.randn(*s, dtype=torch.bfloat16) * 0.05)(B, S, D)),
        "qw_packed": _w(packed),
        "scales": _w(torch.abs((lambda *s: torch.randn(*s, dtype=torch.bfloat16) * 0.05)(ng, F)).to(float) * 0.1 + 0.01),
        "zeros": _w(torch.randint(0, qmax, (ng, F)).to(float)),
        "bits": _w((lambda _x: torch.as_tensor(_x, dtype=torch.int32))(bits)),
    }

def reference(x, qw_packed, scales, zeros, bits):
    b = int(bits)
    pf = 32 // b
    mask = (1 << b) - 1
    P, F = qw_packed.shape
    D = P * pf
    ng = scales.shape[0]
    G = D // ng
    shifts = (lambda x, dt: x.to(dt))(torch.arange(pf) * b, qw_packed.dtype)
    qw = ((qw_packed[:, None, :] >> shifts[None, :, None]) & mask).reshape(D, F)
    s = (lambda x, n, axis: torch.repeat_interleave(x, n, dim=axis))(scales, G, axis=0)
    z = (lambda x, n, axis: torch.repeat_interleave(x, n, dim=axis))(zeros, G, axis=0)
    w = ((lambda x, dt: x.to(dt))(qw, x.dtype) - z) * s
    return torch.einsum("bsd,df->bsf", x, w)
```

```asm
; @launch grid=(256,1,1) block=(512,1,1) lds=111616
.amdgcn_target "amdgcn-amd-amdhsa--gfx950"
.text
.globl standalone__weight_only_int_gptq__prompt_kernel
.p2align 8
.type standalone__weight_only_int_gptq__prompt_kernel,@function
standalone__weight_only_int_gptq__prompt_kernel:
    s_load_dwordx8 s[64:71], s[0:1], 0
    s_load_dwordx2 s[72:73], s[0:1], 40
    s_cmp_ge_u32 s2, 256
    s_cbranch_scc1 L_done
    s_getpc_b64 s[50:51]
L_pc:
    v_lshlrev_b32 v2, 7, v0
    v_min_u32 v2, L_end - L_pc - 4, v2
    v_mov_b32 v3, s51
    v_add_co_u32 v2, vcc, s50, v2
    v_lshrrev_b32 v1, 6, v0
    v_and_b32 v15, 63, v0
    v_addc_co_u32 v3, vcc, 0, v3, vcc
    v_readfirstlane_b32 s28, v1
    s_nop 3
    s_cmp_ge_u32 s28, 4
    s_cbranch_scc1 L_nocpf
    global_load_dword v20, v[2:3], off
L_nocpf:
    s_and_b32 s41, s2, 3
    s_bfe_u32 s42, s2, 0x10002
    s_lshr_b32 s43, s2, 3
    s_lshl_b32 s31, s41, 3
    s_and_b32 s41, s43, 7
    s_add_u32 s31, s31, s41
    s_lshl_b32 s32, s42, 2
    s_lshr_b32 s41, s43, 3
    s_add_u32 s32, s32, s41
    s_and_b32 s29, s28, 3
    s_lshr_b32 s30, s28, 2
    v_and_b32 v16, 15, v0
    v_bfe_u32 v17, v0, 4, 2
    v_mul_u32_u24 v4, 18432, v17
    s_mul_i32 s42, s32, 2304
    v_lshl_add_u32 v21, v16, 3, v4
    v_lshl_add_u32 v4, v16, 4, v4
    s_lshl_b32 s43, s28, 8
    s_add_u32 s43, s43, s42
    v_add_u32 v4, s43, v4
    s_lshr_b32 s43, s29, 1
    s_lshl_b32 s43, s43, 7
    s_add_u32 s43, s43, s42
    s_add_u32 s43, s43, 2048
    v_add_u32 v21, s43, v21
    s_mov_b32 s80, 0
    s_mov_b32 s81, 73728
    s_mov_b32 s82, 147456
    s_mov_b32 s83, 221184
    s_mov_b32 s84, 294912
    s_mov_b32 s85, 368640
    s_mov_b32 s86, 442368
    s_mov_b32 s87, 516096
    s_mov_b32 s88, 589824
    s_mov_b32 s89, 663552
    s_mov_b32 s90, 737280
    s_mov_b32 s91, 811008
    s_mov_b32 s92, 884736
    s_mov_b32 s93, 958464
    s_mov_b32 s94, 1032192
    s_mov_b32 s95, 1105920
    s_mov_b32 s96, 1179648
    s_mov_b32 s97, 1253376
    s_mul_i32 s48, s31, 73728
    s_add_u32 s49, s48, 9216
    s_cmp_lg_u32 s30, 0
    s_cbranch_scc1 L_stage
    s_lshr_b32 s41, s2, 6
    s_lshl_b32 s41, s41, 4
    v_add_u32 v1, s41, v16
    v_mul_u32_u24 v24, 1152, v1
    s_lshl_b32 s42, s29, 1
    s_add_u32 s42, s42, 1
    v_add_u32 v1, s42, v17
    v_lshl_add_u32 v24, v1, 7, v24
    v_mov_b32 v26, 0x7ff00000
    v_cmp_gt_u32 vcc, 32, v15
    v_mul_u32_u24 v1, 3641, v15
    v_lshrrev_b32 v1, 16, v1
    v_cndmask_b32 v24, v26, v24, vcc
    v_mul_u32_u24 v27, 18, v1
    v_sub_u32 v27, v15, v27
    v_add_u32 v28, s42, v1
    v_cmp_gt_u32 vcc, 2, v1
    s_bfe_u32 s41, s2, 0x30003
    s_mul_i32 s41, s41, 18432
    v_cndmask_b32 v28, 0, v28, vcc
    s_mul_i32 s43, s32, 2304
    s_add_u32 s41, s41, s43
    s_mov_b32 s43, 147456
    v_mul_lo_u32 v25, v28, s43
    v_lshl_add_u32 v25, v27, 7, v25
    v_add_u32 v25, s41, v25
    s_cmp_eq_u32 s29, 0
    s_cselect_b32 s43, 54, 36
    v_cmp_gt_u32 vcc, s43, v15
    v_min_u32 v1, 143, v0
    v_lshlrev_b32 v29, 3, v1
    v_cndmask_b32 v25, v26, v25, vcc
    s_mul_i32 s42, s32, 1152
    s_waitcnt lgkmcnt(0)
    s_mov_b32 s12, s66
    s_and_b32 s13, s67, 0xffff
    s_mov_b32 s14, 1327104
    s_mov_b32 s15, 0x00020000
    buffer_load_dwordx4 v[36:39], v4, s[12:15], s80 offen
    buffer_load_dwordx4 v[40:43], v4, s[12:15], s81 offen
    buffer_load_dwordx4 v[44:47], v4, s[12:15], s82 offen
    buffer_load_dwordx4 v[48:51], v4, s[12:15], s83 offen
    buffer_load_dwordx4 v[52:55], v4, s[12:15], s84 offen
    buffer_load_dwordx4 v[56:59], v4, s[12:15], s85 offen
    s_mov_b32 s8, s64
    s_and_b32 s9, s65, 0xffff
    s_mov_b32 s10, 2359296
    s_mov_b32 s11, 0x00020000
    s_mov_b32 s16, s68
    s_and_b32 s17, s69, 0xffff
    s_mov_b32 s18, 9216
    s_mov_b32 s19, 0x00020000
    s_mov_b32 s20, s70
    s_and_b32 s21, s71, 0xffff
    s_mov_b32 s22, 9216
    s_mov_b32 s23, 0x00020000
    buffer_load_dwordx2 v[236:237], v29, s[16:19], s42 offen
    buffer_load_dwordx2 v[238:239], v29, s[20:23], s42 offen
    s_mov_b32 s24, s72
    s_and_b32 s25, s73, 0xffff
    s_mov_b32 s26, 18874368
    s_mov_b32 s27, 0x00020000
    v_lshlrev_b32 v29, 1, v29
    v_add_u32 v248, 73728, v29
    s_mov_b32 s34, 0x000f000f
    v_mov_b32 v5, 0x43004300
    s_mul_i32 s33, s31, 589824
    s_mul_i32 s42, s32, 1152
    s_add_u32 s33, s33, s42
    v_mul_u32_u24 v18, 1152, v16
    v_lshrrev_b32 v1, 1, v16
    v_xor_b32 v1, v1, v17
    v_lshl_add_u32 v2, v1, 4, v18
    v_xor_b32 v1, 4, v1
    v_lshl_add_u32 v3, v1, 4, v18
    s_lshl_b32 s42, s28, 12
    s_add_u32 s42, s42, 78848
    v_and_b32 v1, 7, v16
    v_lshlrev_b32 v18, 1, v17
    v_xor_b32 v1, v1, v18
    v_lshlrev_b32 v18, 7, v16
    v_add_u32 v18, s42, v18
    v_lshl_add_u32 v10, v1, 4, v18
    v_xor_b32 v1, 1, v1
    v_lshl_add_u32 v11, v1, 4, v18
    v_lshrrev_b32 v1, 3, v15
    v_and_b32 v18, 7, v15
    v_xor_b32 v12, v1, v18
    v_lshlrev_b32 v12, 4, v12
    v_lshl_add_u32 v12, v1, 7, v12
    v_add_u32 v12, s42, v12
    v_mul_u32_u24 v13, 9216, v1
    v_lshl_add_u32 v13, v18, 4, v13
    s_lshl_b32 s42, s28, 8
    s_add_u32 s42, s42, 73728
    v_lshl_add_u32 v14, v17, 6, s42
    v_lshlrev_b32 v19, 2, v16
    v_add_u32 v19, 78336, v19
    s_lshl_b32 s41, s28, 7
    s_add_u32 s52, s33, s41
    s_add_u32 s53, s52, 73728
    s_add_u32 s54, s52, 147456
    s_add_u32 s55, s52, 221184
    s_add_u32 s56, s52, 294912
    s_add_u32 s57, s52, 368640
    s_add_u32 s58, s52, 442368
    s_add_u32 s59, s52, 516096
    s_waitcnt vmcnt(7)
    v_lshrrev_b64 v[22:23], 4, v[36:37]
    v_lshrrev_b64 v[24:25], 8, v[36:37]
    v_lshrrev_b64 v[26:27], 12, v[36:37]
    v_and_or_b32 v172, v36, s34, v5
    v_and_or_b32 v173, v22, s34, v5
    v_and_or_b32 v174, v24, s34, v5
    v_and_or_b32 v175, v26, s34, v5
    v_and_or_b32 v176, v37, s34, v5
    v_and_or_b32 v177, v23, s34, v5
    v_and_or_b32 v178, v25, s34, v5
    v_and_or_b32 v179, v27, s34, v5
    v_lshrrev_b64 v[28:29], 4, v[38:39]
    v_lshrrev_b64 v[30:31], 8, v[38:39]
    v_lshrrev_b64 v[32:33], 12, v[38:39]
    v_and_or_b32 v180, v38, s34, v5
    v_and_or_b32 v181, v28, s34, v5
    v_and_or_b32 v182, v30, s34, v5
    v_and_or_b32 v183, v32, s34, v5
    v_and_or_b32 v184, v39, s34, v5
    v_and_or_b32 v185, v29, s34, v5
    v_and_or_b32 v186, v31, s34, v5
    v_and_or_b32 v187, v33, s34, v5
    s_setprio 2
    s_barrier
    ds_read_b128 v[204:207], v2 offset:0
    ds_read_b128 v[208:211], v2 offset:18432
    ds_read_b128 v[212:215], v2 offset:36864
    ds_read_b128 v[216:219], v2 offset:55296
.p2align 3
    s_waitcnt vmcnt(6)
    s_waitcnt lgkmcnt(0)
    v_mfma_f32_16x16x32_bf16 v[108:111], v[172:175], v[204:207], 0
    ds_read_b128 v[220:223], v3 offset:0
    v_lshrrev_b64 v[22:23], 4, v[40:41]
    v_mfma_f32_16x16x32_bf16 v[124:127], v[172:175], v[208:211], 0
    v_lshrrev_b64 v[24:25], 8, v[40:41]
    v_lshrrev_b64 v[26:27], 12, v[40:41]
    v_mfma_f32_16x16x32_bf16 v[140:143], v[172:175], v[212:215], 0
    ds_read_b128 v[224:227], v3 offset:18432
    v_and_or_b32 v188, v40, s34, v5
    v_mfma_f32_16x16x32_bf16 v[156:159], v[172:175], v[216:219], 0
    v_and_or_b32 v189, v22, s34, v5
    v_and_or_b32 v190, v24, s34, v5
    v_mfma_f32_16x16x32_bf16 v[112:115], v[176:179], v[204:207], 0
    ds_read_b128 v[228:231], v3 offset:36864
    v_and_or_b32 v191, v26, s34, v5
    v_mfma_f32_16x16x32_bf16 v[128:131], v[176:179], v[208:211], 0
    v_and_or_b32 v192, v41, s34, v5
    v_and_or_b32 v193, v23, s34, v5
    v_mfma_f32_16x16x32_bf16 v[144:147], v[176:179], v[212:215], 0
    ds_read_b128 v[232:235], v3 offset:55296
    v_and_or_b32 v194, v25, s34, v5
    v_mfma_f32_16x16x32_bf16 v[160:163], v[176:179], v[216:219], 0
    v_and_or_b32 v195, v27, s34, v5
    v_lshrrev_b64 v[28:29], 4, v[42:43]
    v_mfma_f32_16x16x32_bf16 v[116:119], v[180:183], v[204:207], 0
    buffer_load_dwordx4 v[60:63], v4, s[12:15], s86 offen
    v_mfma_f32_16x16x32_bf16 v[132:135], v[180:183], v[208:211], 0
    v_lshrrev_b64 v[30:31], 8, v[42:43]
    v_lshrrev_b64 v[32:33], 12, v[42:43]
    v_mfma_f32_16x16x32_bf16 v[148:151], v[180:183], v[212:215], 0
    v_and_or_b32 v196, v42, s34, v5
    v_and_or_b32 v197, v28, s34, v5
    v_mfma_f32_16x16x32_bf16 v[164:167], v[180:183], v[216:219], 0
    v_and_or_b32 v198, v30, s34, v5
    v_and_or_b32 v199, v32, s34, v5
    v_mfma_f32_16x16x32_bf16 v[120:123], v[184:187], v[204:207], 0
    v_and_or_b32 v200, v43, s34, v5
    v_and_or_b32 v201, v29, s34, v5
    v_mfma_f32_16x16x32_bf16 v[136:139], v[184:187], v[208:211], 0
    v_and_or_b32 v202, v31, s34, v5
    v_and_or_b32 v203, v33, s34, v5
    v_mfma_f32_16x16x32_bf16 v[152:155], v[184:187], v[212:215], 0
    v_mfma_f32_16x16x32_bf16 v[168:171], v[184:187], v[216:219], 0
    s_waitcnt vmcnt(6)
    s_waitcnt lgkmcnt(0)
    v_mfma_f32_16x16x32_bf16 v[108:111], v[188:191], v[220:223], v[108:111]
    ds_read_b128 v[204:207], v2 offset:128
    v_lshrrev_b64 v[22:23], 4, v[44:45]
    v_mfma_f32_16x16x32_bf16 v[124:127], v[188:191], v[224:227], v[124:127]
    v_lshrrev_b64 v[24:25], 8, v[44:45]
    v_lshrrev_b64 v[26:27], 12, v[44:45]
    v_mfma_f32_16x16x32_bf16 v[140:143], v[188:191], v[228:231], v[140:143]
    ds_read_b128 v[208:211], v2 offset:18560
    v_and_or_b32 v172, v44, s34, v5
    v_mfma_f32_16x16x32_bf16 v[156:159], v[188:191], v[232:235], v[156:159]
    v_and_or_b32 v173, v22, s34, v5
    v_and_or_b32 v174, v24, s34, v5
    v_mfma_f32_16x16x32_bf16 v[112:115], v[192:195], v[220:223], v[112:115]
    ds_read_b128 v[212:215], v2 offset:36992
    v_and_or_b32 v175, v26, s34, v5
    v_mfma_f32_16x16x32_bf16 v[128:131], v[192:195], v[224:227], v[128:131]
    v_and_or_b32 v176, v45, s34, v5
    v_and_or_b32 v177, v23, s34, v5
    v_mfma_f32_16x16x32_bf16 v[144:147], v[192:195], v[228:231], v[144:147]
    ds_read_b128 v[216:219], v2 offset:55424
    v_and_or_b32 v178, v25, s34, v5
    v_mfma_f32_16x16x32_bf16 v[160:163], v[192:195], v[232:235], v[160:163]
    v_and_or_b32 v179, v27, s34, v5
    v_lshrrev_b64 v[28:29], 4, v[46:47]
    v_mfma_f32_16x16x32_bf16 v[116:119], v[196:199], v[220:223], v[116:119]
    buffer_load_dwordx4 v[64:67], v4, s[12:15], s87 offen
    v_mfma_f32_16x16x32_bf16 v[132:135], v[196:199], v[224:227], v[132:135]
    v_lshrrev_b64 v[30:31], 8, v[46:47]
    v_lshrrev_b64 v[32:33], 12, v[46:47]
    v_mfma_f32_16x16x32_bf16 v[148:151], v[196:199], v[228:231], v[148:151]
    v_and_or_b32 v180, v46, s34, v5
    v_and_or_b32 v181, v28, s34, v5
    v_mfma_f32_16x16x32_bf16 v[164:167], v[196:199], v[232:235], v[164:167]
    v_and_or_b32 v182, v30, s34, v5
    v_and_or_b32 v183, v32, s34, v5
    v_mfma_f32_16x16x32_bf16 v[120:123], v[200:203], v[220:223], v[120:123]
    v_and_or_b32 v184, v47, s34, v5
    v_and_or_b32 v185, v29, s34, v5
    v_mfma_f32_16x16x32_bf16 v[136:139], v[200:203], v[224:227], v[136:139]
    v_and_or_b32 v186, v31, s34, v5
    v_and_or_b32 v187, v33, s34, v5
    v_mfma_f32_16x16x32_bf16 v[152:155], v[200:203], v[228:231], v[152:155]
    v_mfma_f32_16x16x32_bf16 v[168:171], v[200:203], v[232:235], v[168:171]
    s_waitcnt vmcnt(6)
    s_waitcnt lgkmcnt(0)
    v_mfma_f32_16x16x32_bf16 v[108:111], v[172:175], v[204:207], v[108:111]
    ds_read_b128 v[220:223], v3 offset:128
    v_lshrrev_b64 v[22:23], 4, v[48:49]
    v_mfma_f32_16x16x32_bf16 v[124:127], v[172:175], v[208:211], v[124:127]
    v_lshrrev_b64 v[24:25], 8, v[48:49]
    v_lshrrev_b64 v[26:27], 12, v[48:49]
    v_mfma_f32_16x16x32_bf16 v[140:143], v[172:175], v[212:215], v[140:143]
    ds_read_b128 v[224:227], v3 offset:18560
    v_and_or_b32 v188, v48, s34, v5
    v_mfma_f32_16x16x32_bf16 v[156:159], v[172:175], v[216:219], v[156:159]
    v_and_or_b32 v189, v22, s34, v5
    v_and_or_b32 v190, v24, s34, v5
    v_mfma_f32_16x16x32_bf16 v[112:115], v[176:179], v[204:207], v[112:115]
    ds_read_b128 v[228:231], v3 offset:36992
    v_and_or_b32 v191, v26, s34, v5
    v_mfma_f32_16x16x32_bf16 v[128:131], v[176:179], v[208:211], v[128:131]
    v_and_or_b32 v192, v49, s34, v5
    v_and_or_b32 v193, v23, s34, v5
    v_mfma_f32_16x16x32_bf16 v[144:147], v[176:179], v[212:215], v[144:147]
    ds_read_b128 v[232:235], v3 offset:55424
    v_and_or_b32 v194, v25, s34, v5
    v_mfma_f32_16x16x32_bf16 v[160:163], v[176:179], v[216:219], v[160:163]
    v_and_or_b32 v195, v27, s34, v5
    v_lshrrev_b64 v[28:29], 4, v[50:51]
    v_mfma_f32_16x16x32_bf16 v[116:119], v[180:183], v[204:207], v[116:119]
    buffer_load_dwordx4 v[68:71], v4, s[12:15], s88 offen
    v_mfma_f32_16x16x32_bf16 v[132:135], v[180:183], v[208:211], v[132:135]
    v_lshrrev_b64 v[30:31], 8, v[50:51]
    v_lshrrev_b64 v[32:33], 12, v[50:51]
    v_mfma_f32_16x16x32_bf16 v[148:151], v[180:183], v[212:215], v[148:151]
    v_and_or_b32 v196, v50, s34, v5
    v_and_or_b32 v197, v28, s34, v5
    v_mfma_f32_16x16x32_bf16 v[164:167], v[180:183], v[216:219], v[164:167]
    v_and_or_b32 v198, v30, s34, v5
    v_and_or_b32 v199, v32, s34, v5
    v_mfma_f32_16x16x32_bf16 v[120:123], v[184:187], v[204:207], v[120:123]
    v_and_or_b32 v200, v51, s34, v5
    v_and_or_b32 v201, v29, s34, v5
    v_mfma_f32_16x16x32_bf16 v[136:139], v[184:187], v[208:211], v[136:139]
    v_and_or_b32 v202, v31, s34, v5
    v_and_or_b32 v203, v33, s34, v5
    v_mfma_f32_16x16x32_bf16 v[152:155], v[184:187], v[212:215], v[152:155]
    v_mfma_f32_16x16x32_bf16 v[168:171], v[184:187], v[216:219], v[168:171]
    s_barrier
    s_waitcnt vmcnt(6)
    s_waitcnt lgkmcnt(0)
    s_nop 0
    v_mfma_f32_16x16x32_bf16 v[108:111], v[188:191], v[220:223], v[108:111]
    ds_read_b128 v[204:207], v2 offset:256
    v_lshrrev_b64 v[22:23], 4, v[52:53]
    v_mfma_f32_16x16x32_bf16 v[124:127], v[188:191], v[224:227], v[124:127]
    v_lshrrev_b64 v[24:25], 8, v[52:53]
    v_lshrrev_b64 v[26:27], 12, v[52:53]
    v_mfma_f32_16x16x32_bf16 v[140:143], v[188:191], v[228:231], v[140:143]
    ds_read_b128 v[208:211], v2 offset:18688
    v_and_or_b32 v172, v52, s34, v5
    v_mfma_f32_16x16x32_bf16 v[156:159], v[188:191], v[232:235], v[156:159]
    v_and_or_b32 v173, v22, s34, v5
    v_and_or_b32 v174, v24, s34, v5
    v_mfma_f32_16x16x32_bf16 v[112:115], v[192:195], v[220:223], v[112:115]
    ds_read_b128 v[212:215], v2 offset:37120
    v_and_or_b32 v175, v26, s34, v5
    v_mfma_f32_16x16x32_bf16 v[128:131], v[192:195], v[224:227], v[128:131]
    v_and_or_b32 v176, v53, s34, v5
    v_and_or_b32 v177, v23, s34, v5
    v_mfma_f32_16x16x32_bf16 v[144:147], v[192:195], v[228:231], v[144:147]
    ds_read_b128 v[216:219], v2 offset:55552
    v_and_or_b32 v178, v25, s34, v5
    v_mfma_f32_16x16x32_bf16 v[160:163], v[192:195], v[232:235], v[160:163]
    v_and_or_b32 v179, v27, s34, v5
    v_lshrrev_b64 v[28:29], 4, v[54:55]
    v_mfma_f32_16x16x32_bf16 v[116:119], v[196:199], v[220:223], v[116:119]
    buffer_load_dwordx4 v[72:75], v4, s[12:15], s89 offen
    v_mfma_f32_16x16x32_bf16 v[132:135], v[196:199], v[224:227], v[132:135]
    v_lshrrev_b64 v[30:31], 8, v[54:55]
    v_lshrrev_b64 v[32:33], 12, v[54:55]
    v_mfma_f32_16x16x32_bf16 v[148:151], v[196:199], v[228:231], v[148:151]
    v_and_or_b32 v180, v54, s34, v5
    v_and_or_b32 v181, v28, s34, v5
    v_mfma_f32_16x16x32_bf16 v[164:167], v[196:199], v[232:235], v[164:167]
    v_and_or_b32 v182, v30, s34, v5
    v_and_or_b32 v183, v32, s34, v5
    v_mfma_f32_16x16x32_bf16 v[120:123], v[200:203], v[220:223], v[120:123]
    v_and_or_b32 v184, v55, s34, v5
    v_and_or_b32 v185, v29, s34, v5
    v_mfma_f32_16x16x32_bf16 v[136:139], v[200:203], v[224:227], v[136:139]
    v_and_or_b32 v186, v31, s34, v5
    v_and_or_b32 v187, v33, s34, v5
    v_mfma_f32_16x16x32_bf16 v[152:155], v[200:203], v[228:231], v[152:155]
    v_mfma_f32_16x16x32_bf16 v[168:171], v[200:203], v[232:235], v[168:171]
    s_waitcnt vmcnt(6)
    s_waitcnt lgkmcnt(0)
    v_mfma_f32_16x16x32_bf16 v[108:111], v[172:175], v[204:207], v[108:111]
    ds_read_b128 v[220:223], v3 offset:256
    v_lshrrev_b64 v[22:23], 4, v[56:57]
    v_mfma_f32_16x16x32_bf16 v[124:127], v[172:175], v[208:211], v[124:127]
    v_lshrrev_b64 v[24:25], 8, v[56:57]
    v_lshrrev_b64 v[26:27], 12, v[56:57]
    v_mfma_f32_16x16x32_bf16 v[140:143], v[172:175], v[212:215], v[140:143]
    ds_read_b128 v[224:227], v3 offset:18688
    v_and_or_b32 v188, v56, s34, v5
    v_mfma_f32_16x16x32_bf16 v[156:159], v[172:175], v[216:219], v[156:159]
    v_and_or_b32 v189, v22, s34, v5
    v_and_or_b32 v190, v24, s34, v5
    v_mfma_f32_16x16x32_bf16 v[112:115], v[176:179], v[204:207], v[112:115]
    ds_read_b128 v[228:231], v3 offset:37120
    v_and_or_b32 v191, v26, s34, v5
    v_mfma_f32_16x16x32_bf16 v[128:131], v[176:179], v[208:211], v[128:131]
    v_and_or_b32 v192, v57, s34, v5
    v_and_or_b32 v193, v23, s34, v5
    v_mfma_f32_16x16x32_bf16 v[144:147], v[176:179], v[212:215], v[144:147]
    ds_read_b128 v[232:235], v3 offset:55552
    v_and_or_b32 v194, v25, s34, v5
    v_mfma_f32_16x16x32_bf16 v[160:163], v[176:179], v[216:219], v[160:163]
    v_and_or_b32 v195, v27, s34, v5
    v_lshrrev_b64 v[28:29], 4, v[58:59]
    v_mfma_f32_16x16x32_bf16 v[116:119], v[180:183], v[204:207], v[116:119]
    buffer_load_dwordx4 v[76:79], v4, s[12:15], s90 offen
    v_mfma_f32_16x16x32_bf16 v[132:135], v[180:183], v[208:211], v[132:135]
    v_lshrrev_b64 v[30:31], 8, v[58:59]
    v_lshrrev_b64 v[32:33], 12, v[58:59]
    v_mfma_f32_16x16x32_bf16 v[148:151], v[180:183], v[212:215], v[148:151]
    v_and_or_b32 v196, v58, s34, v5
    v_and_or_b32 v197, v28, s34, v5
    v_mfma_f32_16x16x32_bf16 v[164:167], v[180:183], v[216:219], v[164:167]
    v_and_or_b32 v198, v30, s34, v5
    v_and_or_b32 v199, v32, s34, v5
    v_mfma_f32_16x16x32_bf16 v[120:123], v[184:187], v[204:207], v[120:123]
    v_and_or_b32 v200, v59, s34, v5
    v_and_or_b32 v201, v29, s34, v5
    v_mfma_f32_16x16x32_bf16 v[136:139], v[184:187], v[208:211], v[136:139]
    v_and_or_b32 v202, v31, s34, v5
    v_and_or_b32 v203, v33, s34, v5
    v_mfma_f32_16x16x32_bf16 v[152:155], v[184:187], v[212:215], v[152:155]
    v_mfma_f32_16x16x32_bf16 v[168:171], v[184:187], v[216:219], v[168:171]
    s_waitcnt vmcnt(4)
    s_waitcnt lgkmcnt(0)
    v_mfma_f32_16x16x32_bf16 v[108:111], v[188:191], v[220:223], v[108:111]
    ds_read_b128 v[204:207], v2 offset:384
    v_lshrrev_b64 v[22:23], 4, v[60:61]
    v_mfma_f32_16x16x32_bf16 v[124:127], v[188:191], v[224:227], v[124:127]
    v_lshrrev_b64 v[24:25], 8, v[60:61]
    v_lshrrev_b64 v[26:27], 12, v[60:61]
    v_mfma_f32_16x16x32_bf16 v[140:143], v[188:191], v[228:231], v[140:143]
    ds_read_b128 v[208:211], v2 offset:18816
    v_and_or_b32 v172, v60, s34, v5
    v_mfma_f32_16x16x32_bf16 v[156:159], v[188:191], v[232:235], v[156:159]
    v_and_or_b32 v173, v22, s34, v5
    v_and_or_b32 v174, v24, s34, v5
    v_mfma_f32_16x16x32_bf16 v[112:115], v[192:195], v[220:223], v[112:115]
    ds_read_b128 v[212:215], v2 offset:37248
    v_and_or_b32 v175, v26, s34, v5
    v_mfma_f32_16x16x32_bf16 v[128:131], v[192:195], v[224:227], v[128:131]
    v_and_or_b32 v176, v61, s34, v5
    v_and_or_b32 v177, v23, s34, v5
    v_mfma_f32_16x16x32_bf16 v[144:147], v[192:195], v[228:231], v[144:147]
    ds_read_b128 v[216:219], v2 offset:55680
    v_and_or_b32 v178, v25, s34, v5
    v_mfma_f32_16x16x32_bf16 v[160:163], v[192:195], v[232:235], v[160:163]
    v_and_or_b32 v179, v27, s34, v5
    v_lshrrev_b64 v[28:29], 4, v[62:63]
    v_mfma_f32_16x16x32_bf16 v[116:119], v[196:199], v[220:223], v[116:119]
    buffer_load_dwordx4 v[80:83], v4, s[12:15], s91 offen
    v_mfma_f32_16x16x32_bf16 v[132:135], v[196:199], v[224:227], v[132:135]
    v_lshrrev_b64 v[30:31], 8, v[62:63]
    v_lshrrev_b64 v[32:33], 12, v[62:63]
    v_mfma_f32_16x16x32_bf16 v[148:151], v[196:199], v[228:231], v[148:151]
    v_and_or_b32 v180, v62, s34, v5
    v_and_or_b32 v181, v28, s34, v5
    v_mfma_f32_16x16x32_bf16 v[164:167], v[196:199], v[232:235], v[164:167]
    v_and_or_b32 v182, v30, s34, v5
    v_and_or_b32 v183, v32, s34, v5
    v_mfma_f32_16x16x32_bf16 v[120:123], v[200:203], v[220:223], v[120:123]
    v_and_or_b32 v184, v63, s34, v5
    v_and_or_b32 v185, v29, s34, v5
    v_mfma_f32_16x16x32_bf16 v[136:139], v[200:203], v[224:227], v[136:139]
    v_and_or_b32 v186, v31, s34, v5
    v_and_or_b32 v187, v33, s34, v5
    v_mfma_f32_16x16x32_bf16 v[152:155], v[200:203], v[228:231], v[152:155]
    v_mfma_f32_16x16x32_bf16 v[168:171], v[200:203], v[232:235], v[168:171]
    s_waitcnt vmcnt(4)
    s_waitcnt vmcnt(7)
    s_waitcnt lgkmcnt(0)
    s_nop 0
    v_mfma_f32_16x16x32_bf16 v[108:111], v[172:175], v[204:207], v[108:111]
    ds_read_b128 v[220:223], v3 offset:384
    v_lshrrev_b64 v[22:23], 4, v[64:65]
    v_lshrrev_b64 v[24:25], 8, v[64:65]
    v_mfma_f32_16x16x32_bf16 v[124:127], v[172:175], v[208:211], v[124:127]
    v_lshrrev_b64 v[26:27], 12, v[64:65]
    v_and_or_b32 v188, v64, s34, v5
    v_and_or_b32 v189, v22, s34, v5
    v_mfma_f32_16x16x32_bf16 v[140:143], v[172:175], v[212:215], v[140:143]
    ds_read_b128 v[224:227], v3 offset:18816
    v_and_or_b32 v190, v24, s34, v5
    v_and_or_b32 v191, v26, s34, v5
    v_mfma_f32_16x16x32_bf16 v[156:159], v[172:175], v[216:219], v[156:159]
    v_and_or_b32 v192, v65, s34, v5
    v_and_or_b32 v193, v23, s34, v5
    v_and_or_b32 v194, v25, s34, v5
    v_mfma_f32_16x16x32_bf16 v[112:115], v[176:179], v[204:207], v[112:115]
    ds_read_b128 v[228:231], v3 offset:37248
    v_and_or_b32 v195, v27, s34, v5
    v_lshrrev_b64 v[28:29], 4, v[66:67]
    v_mfma_f32_16x16x32_bf16 v[128:131], v[176:179], v[208:211], v[128:131]
    v_lshrrev_b64 v[30:31], 8, v[66:67]
    v_lshrrev_b64 v[32:33], 12, v[66:67]
    v_and_or_b32 v196, v66, s34, v5
    v_mfma_f32_16x16x32_bf16 v[144:147], v[176:179], v[212:215], v[144:147]
    ds_read_b128 v[232:235], v3 offset:55680
    v_and_or_b32 v197, v28, s34, v5
    v_and_or_b32 v198, v30, s34, v5
    v_mfma_f32_16x16x32_bf16 v[160:163], v[176:179], v[216:219], v[160:163]
    v_and_or_b32 v199, v32, s34, v5
    v_and_or_b32 v200, v67, s34, v5
    v_and_or_b32 v201, v29, s34, v5
    v_mfma_f32_16x16x32_bf16 v[116:119], v[180:183], v[204:207], v[116:119]
    buffer_load_dwordx4 v[84:87], v4, s[12:15], s92 offen
    v_and_or_b32 v202, v31, s34, v5
    v_mfma_f32_16x16x32_bf16 v[132:135], v[180:183], v[208:211], v[132:135]
    v_and_or_b32 v203, v33, s34, v5
    v_lshlrev_b32 v240, 16, v236
    v_and_b32 v241, 0xffff0000, v236
    v_mfma_f32_16x16x32_bf16 v[148:151], v[180:183], v[212:215], v[148:151]
    v_lshlrev_b32 v242, 16, v237
    v_and_b32 v243, 0xffff0000, v237
    v_lshlrev_b32 v244, 16, v238
    v_mfma_f32_16x16x32_bf16 v[164:167], v[180:183], v[216:219], v[164:167]
    v_and_b32 v245, 0xffff0000, v238
    v_lshlrev_b32 v246, 16, v239
    v_and_b32 v247, 0xffff0000, v239
    v_mfma_f32_16x16x32_bf16 v[120:123], v[184:187], v[204:207], v[120:123]
    v_add_f32 v244, 0x43000000, v244
    v_add_f32 v245, 0x43000000, v245
    v_add_f32 v246, 0x43000000, v246
    v_mfma_f32_16x16x32_bf16 v[136:139], v[184:187], v[208:211], v[136:139]
    v_add_f32 v247, 0x43000000, v247
    ds_write_b128 v248, v[240:243]
    ds_write_b128 v248, v[244:247] offset:2304
    v_mfma_f32_16x16x32_bf16 v[152:155], v[184:187], v[212:215], v[152:155]
    v_mfma_f32_16x16x32_bf16 v[168:171], v[184:187], v[216:219], v[168:171]
    s_barrier
    s_waitcnt vmcnt(4)
    s_waitcnt lgkmcnt(0)
    s_nop 0
    v_mfma_f32_16x16x32_bf16 v[108:111], v[188:191], v[220:223], v[108:111]
    ds_read_b128 v[204:207], v2 offset:512
    v_lshrrev_b64 v[22:23], 4, v[68:69]
    v_mfma_f32_16x16x32_bf16 v[124:127], v[188:191], v[224:227], v[124:127]
    v_lshrrev_b64 v[24:25], 8, v[68:69]
    v_lshrrev_b64 v[26:27], 12, v[68:69]
    v_mfma_f32_16x16x32_bf16 v[140:143], v[188:191], v[228:231], v[140:143]
    ds_read_b128 v[208:211], v2 offset:18944
    v_and_or_b32 v172, v68, s34, v5
    v_mfma_f32_16x16x32_bf16 v[156:159], v[188:191], v[232:235], v[156:159]
    v_and_or_b32 v173, v22, s34, v5
    v_and_or_b32 v174, v24, s34, v5
    v_mfma_f32_16x16x32_bf16 v[112:115], v[192:195], v[220:223], v[112:115]
    ds_read_b128 v[212:215], v2 offset:37376
    v_and_or_b32 v175, v26, s34, v5
    v_mfma_f32_16x16x32_bf16 v[128:131], v[192:195], v[224:227], v[128:131]
    v_and_or_b32 v176, v69, s34, v5
    v_and_or_b32 v177, v23, s34, v5
    v_mfma_f32_16x16x32_bf16 v[144:147], v[192:195], v[228:231], v[144:147]
    ds_read_b128 v[216:219], v2 offset:55808
    v_and_or_b32 v178, v25, s34, v5
    v_mfma_f32_16x16x32_bf16 v[160:163], v[192:195], v[232:235], v[160:163]
    v_and_or_b32 v179, v27, s34, v5
    v_lshrrev_b64 v[28:29], 4, v[70:71]
    v_mfma_f32_16x16x32_bf16 v[116:119], v[196:199], v[220:223], v[116:119]
    buffer_load_dwordx4 v[88:91], v4, s[12:15], s93 offen
    v_mfma_f32_16x16x32_bf16 v[132:135], v[196:199], v[224:227], v[132:135]
    v_lshrrev_b64 v[30:31], 8, v[70:71]
    v_lshrrev_b64 v[32:33], 12, v[70:71]
    v_mfma_f32_16x16x32_bf16 v[148:151], v[196:199], v[228:231], v[148:151]
    v_and_or_b32 v180, v70, s34, v5
    v_and_or_b32 v181, v28, s34, v5
    v_mfma_f32_16x16x32_bf16 v[164:167], v[196:199], v[232:235], v[164:167]
    v_and_or_b32 v182, v30, s34, v5
    v_and_or_b32 v183, v32, s34, v5
    v_mfma_f32_16x16x32_bf16 v[120:123], v[200:203], v[220:223], v[120:123]
    v_and_or_b32 v184, v71, s34, v5
    v_and_or_b32 v185, v29, s34, v5
    v_mfma_f32_16x16x32_bf16 v[136:139], v[200:203], v[224:227], v[136:139]
    v_and_or_b32 v186, v31, s34, v5
    v_and_or_b32 v187, v33, s34, v5
    v_mfma_f32_16x16x32_bf16 v[152:155], v[200:203], v[228:231], v[152:155]
    v_mfma_f32_16x16x32_bf16 v[168:171], v[200:203], v[232:235], v[168:171]
    s_waitcnt vmcnt(4)
    s_waitcnt lgkmcnt(0)
    v_mfma_f32_16x16x32_bf16 v[108:111], v[172:175], v[204:207], v[108:111]
    ds_read_b128 v[220:223], v3 offset:512
    v_lshrrev_b64 v[22:23], 4, v[72:73]
    v_mfma_f32_16x16x32_bf16 v[124:127], v[172:175], v[208:211], v[124:127]
    v_lshrrev_b64 v[24:25], 8, v[72:73]
    v_lshrrev_b64 v[26:27], 12, v[72:73]
    v_mfma_f32_16x16x32_bf16 v[140:143], v[172:175], v[212:215], v[140:143]
    ds_read_b128 v[224:227], v3 offset:18944
    v_and_or_b32 v188, v72, s34, v5
    v_mfma_f32_16x16x32_bf16 v[156:159], v[172:175], v[216:219], v[156:159]
    v_and_or_b32 v189, v22, s34, v5
    v_and_or_b32 v190, v24, s34, v5
    v_mfma_f32_16x16x32_bf16 v[112:115], v[176:179], v[204:207], v[112:115]
    ds_read_b128 v[228:231], v3 offset:37376
    v_and_or_b32 v191, v26, s34, v5
    v_mfma_f32_16x16x32_bf16 v[128:131], v[176:179], v[208:211], v[128:131]
    v_and_or_b32 v192, v73, s34, v5
    v_and_or_b32 v193, v23, s34, v5
    v_mfma_f32_16x16x32_bf16 v[144:147], v[176:179], v[212:215], v[144:147]
    ds_read_b128 v[232:235], v3 offset:55808
    v_and_or_b32 v194, v25, s34, v5
    v_mfma_f32_16x16x32_bf16 v[160:163], v[176:179], v[216:219], v[160:163]
    v_and_or_b32 v195, v27, s34, v5
    v_lshrrev_b64 v[28:29], 4, v[74:75]
    v_mfma_f32_16x16x32_bf16 v[116:119], v[180:183], v[204:207], v[116:119]
    buffer_load_dwordx4 v[92:95], v4, s[12:15], s94 offen
    v_mfma_f32_16x16x32_bf16 v[132:135], v[180:183], v[208:211], v[132:135]
    v_lshrrev_b64 v[30:31], 8, v[74:75]
    v_lshrrev_b64 v[32:33], 12, v[74:75]
    v_mfma_f32_16x16x32_bf16 v[148:151], v[180:183], v[212:215], v[148:151]
    v_and_or_b32 v196, v74, s34, v5
    v_and_or_b32 v197, v28, s34, v5
    v_mfma_f32_16x16x32_bf16 v[164:167], v[180:183], v[216:219], v[164:167]
    v_and_or_b32 v198, v30, s34, v5
    v_and_or_b32 v199, v32, s34, v5
    v_mfma_f32_16x16x32_bf16 v[120:123], v[184:187], v[204:207], v[120:123]
    v_and_or_b32 v200, v75, s34, v5
    v_and_or_b32 v201, v29, s34, v5
    v_mfma_f32_16x16x32_bf16 v[136:139], v[184:187], v[208:211], v[136:139]
    v_and_or_b32 v202, v31, s34, v5
    v_and_or_b32 v203, v33, s34, v5
    v_mfma_f32_16x16x32_bf16 v[152:155], v[184:187], v[212:215], v[152:155]
    v_mfma_f32_16x16x32_bf16 v[168:171], v[184:187], v[216:219], v[168:171]
    s_waitcnt vmcnt(4)
    s_waitcnt lgkmcnt(0)
    v_mfma_f32_16x16x32_bf16 v[108:111], v[188:191], v[220:223], v[108:111]
    ds_read_b128 v[204:207], v2 offset:640
    v_lshrrev_b64 v[22:23], 4, v[76:77]
    v_mfma_f32_16x16x32_bf16 v[124:127], v[188:191], v[224:227], v[124:127]
    v_lshrrev_b64 v[24:25], 8, v[76:77]
    v_lshrrev_b64 v[26:27], 12, v[76:77]
    v_mfma_f32_16x16x32_bf16 v[140:143], v[188:191], v[228:231], v[140:143]
    ds_read_b128 v[208:211], v2 offset:19072
    v_and_or_b32 v172, v76, s34, v5
    v_mfma_f32_16x16x32_bf16 v[156:159], v[188:191], v[232:235], v[156:159]
    v_and_or_b32 v173, v22, s34, v5
    v_and_or_b32 v174, v24, s34, v5
    v_mfma_f32_16x16x32_bf16 v[112:115], v[192:195], v[220:223], v[112:115]
    ds_read_b128 v[212:215], v2 offset:37504
    v_and_or_b32 v175, v26, s34, v5
    v_mfma_f32_16x16x32_bf16 v[128:131], v[192:195], v[224:227], v[128:131]
    v_and_or_b32 v176, v77, s34, v5
    v_and_or_b32 v177, v23, s34, v5
    v_mfma_f32_16x16x32_bf16 v[144:147], v[192:195], v[228:231], v[144:147]
    ds_read_b128 v[216:219], v2 offset:55936
    v_and_or_b32 v178, v25, s34, v5
    v_mfma_f32_16x16x32_bf16 v[160:163], v[192:195], v[232:235], v[160:163]
    v_and_or_b32 v179, v27, s34, v5
    v_lshrrev_b64 v[28:29], 4, v[78:79]
    v_mfma_f32_16x16x32_bf16 v[116:119], v[196:199], v[220:223], v[116:119]
    buffer_load_dwordx4 v[96:99], v4, s[12:15], s95 offen
    v_mfma_f32_16x16x32_bf16 v[132:135], v[196:199], v[224:227], v[132:135]
    v_lshrrev_b64 v[30:31], 8, v[78:79]
    v_lshrrev_b64 v[32:33], 12, v[78:79]
    v_mfma_f32_16x16x32_bf16 v[148:151], v[196:199], v[228:231], v[148:151]
    v_and_or_b32 v180, v78, s34, v5
    v_and_or_b32 v181, v28, s34, v5
    v_mfma_f32_16x16x32_bf16 v[164:167], v[196:199], v[232:235], v[164:167]
    v_and_or_b32 v182, v30, s34, v5
    v_and_or_b32 v183, v32, s34, v5
    v_mfma_f32_16x16x32_bf16 v[120:123], v[200:203], v[220:223], v[120:123]
    v_and_or_b32 v184, v79, s34, v5
    v_and_or_b32 v185, v29, s34, v5
    v_mfma_f32_16x16x32_bf16 v[136:139], v[200:203], v[224:227], v[136:139]
    v_and_or_b32 v186, v31, s34, v5
    v_and_or_b32 v187, v33, s34, v5
    v_mfma_f32_16x16x32_bf16 v[152:155], v[200:203], v[228:231], v[152:155]
    v_mfma_f32_16x16x32_bf16 v[168:171], v[200:203], v[232:235], v[168:171]
    s_waitcnt vmcnt(4)
    s_waitcnt lgkmcnt(0)
    v_mfma_f32_16x16x32_bf16 v[108:111], v[172:175], v[204:207], v[108:111]
    ds_read_b128 v[220:223], v3 offset:640
    v_lshrrev_b64 v[22:23], 4, v[80:81]
    v_mfma_f32_16x16x32_bf16 v[124:127], v[172:175], v[208:211], v[124:127]
    v_lshrrev_b64 v[24:25], 8, v[80:81]
    v_lshrrev_b64 v[26:27], 12, v[80:81]
    v_mfma_f32_16x16x32_bf16 v[140:143], v[172:175], v[212:215], v[140:143]
    ds_read_b128 v[224:227], v3 offset:19072
    v_and_or_b32 v188, v80, s34, v5
    v_mfma_f32_16x16x32_bf16 v[156:159], v[172:175], v[216:219], v[156:159]
    v_and_or_b32 v189, v22, s34, v5
    v_and_or_b32 v190, v24, s34, v5
    v_mfma_f32_16x16x32_bf16 v[112:115], v[176:179], v[204:207], v[112:115]
    ds_read_b128 v[228:231], v3 offset:37504
    v_and_or_b32 v191, v26, s34, v5
    v_mfma_f32_16x16x32_bf16 v[128:131], v[176:179], v[208:211], v[128:131]
    v_and_or_b32 v192, v81, s34, v5
    v_and_or_b32 v193, v23, s34, v5
    v_mfma_f32_16x16x32_bf16 v[144:147], v[176:179], v[212:215], v[144:147]
    ds_read_b128 v[232:235], v3 offset:55936
    v_and_or_b32 v194, v25, s34, v5
    v_mfma_f32_16x16x32_bf16 v[160:163], v[176:179], v[216:219], v[160:163]
    v_and_or_b32 v195, v27, s34, v5
    v_lshrrev_b64 v[28:29], 4, v[82:83]
    v_mfma_f32_16x16x32_bf16 v[116:119], v[180:183], v[204:207], v[116:119]
    buffer_load_dwordx4 v[100:103], v4, s[12:15], s96 offen
    v_mfma_f32_16x16x32_bf16 v[132:135], v[180:183], v[208:211], v[132:135]
    v_lshrrev_b64 v[30:31], 8, v[82:83]
    v_lshrrev_b64 v[32:33], 12, v[82:83]
    v_mfma_f32_16x16x32_bf16 v[148:151], v[180:183], v[212:215], v[148:151]
    buffer_load_dwordx2 v[36:37], v21, s[12:15], s80 offen
    v_mfma_f32_16x16x32_bf16 v[164:167], v[180:183], v[216:219], v[164:167]
    v_and_or_b32 v196, v82, s34, v5
    v_and_or_b32 v197, v28, s34, v5
    v_mfma_f32_16x16x32_bf16 v[120:123], v[184:187], v[204:207], v[120:123]
    buffer_load_dwordx2 v[38:39], v21, s[12:15], s81 offen
    v_mfma_f32_16x16x32_bf16 v[136:139], v[184:187], v[208:211], v[136:139]
    v_and_or_b32 v198, v30, s34, v5
    v_and_or_b32 v199, v32, s34, v5
    v_mfma_f32_16x16x32_bf16 v[152:155], v[184:187], v[212:215], v[152:155]
    buffer_load_dwordx2 v[40:41], v21, s[12:15], s82 offen
    v_mfma_f32_16x16x32_bf16 v[168:171], v[184:187], v[216:219], v[168:171]
    v_and_or_b32 v200, v83, s34, v5
    v_and_or_b32 v201, v29, s34, v5
    v_and_or_b32 v202, v31, s34, v5
    v_and_or_b32 v203, v33, s34, v5
    s_barrier
    s_waitcnt vmcnt(7)
    s_waitcnt lgkmcnt(0)
    s_nop 0
    v_mfma_f32_16x16x32_bf16 v[108:111], v[188:191], v[220:223], v[108:111]
    ds_read_b128 v[204:207], v2 offset:768
    v_lshrrev_b64 v[22:23], 4, v[84:85]
    v_mfma_f32_16x16x32_bf16 v[124:127], v[188:191], v[224:227], v[124:127]
    v_lshrrev_b64 v[24:25], 8, v[84:85]
    v_lshrrev_b64 v[26:27], 12, v[84:85]
    v_mfma_f32_16x16x32_bf16 v[140:143], v[188:191], v[228:231], v[140:143]
    ds_read_b128 v[208:211], v2 offset:19200
    v_and_or_b32 v172, v84, s34, v5
    v_mfma_f32_16x16x32_bf16 v[156:159], v[188:191], v[232:235], v[156:159]
    v_and_or_b32 v173, v22, s34, v5
    v_and_or_b32 v174, v24, s34, v5
    v_mfma_f32_16x16x32_bf16 v[112:115], v[192:195], v[220:223], v[112:115]
    ds_read_b128 v[212:215], v2 offset:37632
    v_and_or_b32 v175, v26, s34, v5
    v_mfma_f32_16x16x32_bf16 v[128:131], v[192:195], v[224:227], v[128:131]
    v_and_or_b32 v176, v85, s34, v5
    v_and_or_b32 v177, v23, s34, v5
    v_mfma_f32_16x16x32_bf16 v[144:147], v[192:195], v[228:231], v[144:147]
    ds_read_b128 v[216:219], v2 offset:56064
    v_and_or_b32 v178, v25, s34, v5
    v_mfma_f32_16x16x32_bf16 v[160:163], v[192:195], v[232:235], v[160:163]
    v_and_or_b32 v179, v27, s34, v5
    v_lshrrev_b64 v[28:29], 4, v[86:87]
    v_mfma_f32_16x16x32_bf16 v[116:119], v[196:199], v[220:223], v[116:119]
    buffer_load_dwordx4 v[104:107], v4, s[12:15], s97 offen
    v_mfma_f32_16x16x32_bf16 v[132:135], v[196:199], v[224:227], v[132:135]
    v_lshrrev_b64 v[30:31], 8, v[86:87]
    v_lshrrev_b64 v[32:33], 12, v[86:87]
    v_mfma_f32_16x16x32_bf16 v[148:151], v[196:199], v[228:231], v[148:151]
    buffer_load_dwordx2 v[42:43], v21, s[12:15], s83 offen
    v_mfma_f32_16x16x32_bf16 v[164:167], v[196:199], v[232:235], v[164:167]
    v_and_or_b32 v180, v86, s34, v5
    v_and_or_b32 v181, v28, s34, v5
    v_mfma_f32_16x16x32_bf16 v[120:123], v[200:203], v[220:223], v[120:123]
    buffer_load_dwordx2 v[44:45], v21, s[12:15], s84 offen
    v_mfma_f32_16x16x32_bf16 v[136:139], v[200:203], v[224:227], v[136:139]
    v_and_or_b32 v182, v30, s34, v5
    v_and_or_b32 v183, v32, s34, v5
    v_mfma_f32_16x16x32_bf16 v[152:155], v[200:203], v[228:231], v[152:155]
    buffer_load_dwordx2 v[46:47], v21, s[12:15], s85 offen
    v_mfma_f32_16x16x32_bf16 v[168:171], v[200:203], v[232:235], v[168:171]
    v_and_or_b32 v184, v87, s34, v5
    v_and_or_b32 v185, v29, s34, v5
    v_and_or_b32 v186, v31, s34, v5
    v_and_or_b32 v187, v33, s34, v5
    s_waitcnt vmcnt(10)
    s_waitcnt lgkmcnt(0)
    v_mfma_f32_16x16x32_bf16 v[108:111], v[172:175], v[204:207], v[108:111]
    ds_read_b128 v[220:223], v3 offset:768
    v_lshrrev_b64 v[22:23], 4, v[88:89]
    v_mfma_f32_16x16x32_bf16 v[124:127], v[172:175], v[208:211], v[124:127]
    v_lshrrev_b64 v[24:25], 8, v[88:89]
    v_lshrrev_b64 v[26:27], 12, v[88:89]
    v_mfma_f32_16x16x32_bf16 v[140:143], v[172:175], v[212:215], v[140:143]
    ds_read_b128 v[224:227], v3 offset:19200
    v_and_or_b32 v188, v88, s34, v5
    v_mfma_f32_16x16x32_bf16 v[156:159], v[172:175], v[216:219], v[156:159]
    v_and_or_b32 v189, v22, s34, v5
    v_and_or_b32 v190, v24, s34, v5
    v_mfma_f32_16x16x32_bf16 v[112:115], v[176:179], v[204:207], v[112:115]
    ds_read_b128 v[228:231], v3 offset:37632
    v_and_or_b32 v191, v26, s34, v5
    v_mfma_f32_16x16x32_bf16 v[128:131], v[176:179], v[208:211], v[128:131]
    v_and_or_b32 v192, v89, s34, v5
    v_and_or_b32 v193, v23, s34, v5
    v_mfma_f32_16x16x32_bf16 v[144:147], v[176:179], v[212:215], v[144:147]
    ds_read_b128 v[232:235], v3 offset:56064
    v_and_or_b32 v194, v25, s34, v5
    v_mfma_f32_16x16x32_bf16 v[160:163], v[176:179], v[216:219], v[160:163]
    v_and_or_b32 v195, v27, s34, v5
    v_lshrrev_b64 v[28:29], 4, v[90:91]
    v_mfma_f32_16x16x32_bf16 v[116:119], v[180:183], v[204:207], v[116:119]
    buffer_load_dwordx2 v[48:49], v21, s[12:15], s86 offen
    v_mfma_f32_16x16x32_bf16 v[132:135], v[180:183], v[208:211], v[132:135]
    v_lshrrev_b64 v[30:31], 8, v[90:91]
    v_lshrrev_b64 v[32:33], 12, v[90:91]
    v_mfma_f32_16x16x32_bf16 v[148:151], v[180:183], v[212:215], v[148:151]
    buffer_load_dwordx2 v[50:51], v21, s[12:15], s87 offen
    v_mfma_f32_16x16x32_bf16 v[164:167], v[180:183], v[216:219], v[164:167]
    v_and_or_b32 v196, v90, s34, v5
    v_and_or_b32 v197, v28, s34, v5
    v_mfma_f32_16x16x32_bf16 v[120:123], v[184:187], v[204:207], v[120:123]
    buffer_load_dwordx2 v[52:53], v21, s[12:15], s88 offen
    v_mfma_f32_16x16x32_bf16 v[136:139], v[184:187], v[208:211], v[136:139]
    v_and_or_b32 v198, v30, s34, v5
    v_and_or_b32 v199, v32, s34, v5
    v_mfma_f32_16x16x32_bf16 v[152:155], v[184:187], v[212:215], v[152:155]
    v_and_or_b32 v200, v91, s34, v5
    v_and_or_b32 v201, v29, s34, v5
    v_mfma_f32_16x16x32_bf16 v[168:171], v[184:187], v[216:219], v[168:171]
    v_and_or_b32 v202, v31, s34, v5
    v_and_or_b32 v203, v33, s34, v5
    s_waitcnt vmcnt(12)
    s_waitcnt lgkmcnt(0)
    v_mfma_f32_16x16x32_bf16 v[108:111], v[188:191], v[220:223], v[108:111]
    ds_read_b128 v[204:207], v2 offset:896
    v_lshrrev_b64 v[22:23], 4, v[92:93]
    v_mfma_f32_16x16x32_bf16 v[124:127], v[188:191], v[224:227], v[124:127]
    v_lshrrev_b64 v[24:25], 8, v[92:93]
    v_lshrrev_b64 v[26:27], 12, v[92:93]
    v_mfma_f32_16x16x32_bf16 v[140:143], v[188:191], v[228:231], v[140:143]
    ds_read_b128 v[208:211], v2 offset:19328
    v_and_or_b32 v172, v92, s34, v5
    v_mfma_f32_16x16x32_bf16 v[156:159], v[188:191], v[232:235], v[156:159]
    v_and_or_b32 v173, v22, s34, v5
    v_and_or_b32 v174, v24, s34, v5
    v_mfma_f32_16x16x32_bf16 v[112:115], v[192:195], v[220:223], v[112:115]
    ds_read_b128 v[212:215], v2 offset:37760
    v_and_or_b32 v175, v26, s34, v5
    v_mfma_f32_16x16x32_bf16 v[128:131], v[192:195], v[224:227], v[128:131]
    v_and_or_b32 v176, v93, s34, v5
    v_and_or_b32 v177, v23, s34, v5
    v_mfma_f32_16x16x32_bf16 v[144:147], v[192:195], v[228:231], v[144:147]
    ds_read_b128 v[216:219], v2 offset:56192
    v_and_or_b32 v178, v25, s34, v5
    v_mfma_f32_16x16x32_bf16 v[160:163], v[192:195], v[232:235], v[160:163]
    v_and_or_b32 v179, v27, s34, v5
    v_lshrrev_b64 v[28:29], 4, v[94:95]
    v_mfma_f32_16x16x32_bf16 v[116:119], v[196:199], v[220:223], v[116:119]
    buffer_load_dwordx2 v[54:55], v21, s[12:15], s89 offen
    v_mfma_f32_16x16x32_bf16 v[132:135], v[196:199], v[224:227], v[132:135]
    v_lshrrev_b64 v[30:31], 8, v[94:95]
    v_lshrrev_b64 v[32:33], 12, v[94:95]
    v_mfma_f32_16x16x32_bf16 v[148:151], v[196:199], v[228:231], v[148:151]
    buffer_load_dwordx2 v[56:57], v21, s[12:15], s90 offen
    v_mfma_f32_16x16x32_bf16 v[164:167], v[196:199], v[232:235], v[164:167]
    v_and_or_b32 v180, v94, s34, v5
    v_and_or_b32 v181, v28, s34, v5
    v_mfma_f32_16x16x32_bf16 v[120:123], v[200:203], v[220:223], v[120:123]
    buffer_load_dwordx2 v[58:59], v21, s[12:15], s91 offen
    v_mfma_f32_16x16x32_bf16 v[136:139], v[200:203], v[224:227], v[136:139]
    v_and_or_b32 v182, v30, s34, v5
    v_and_or_b32 v183, v32, s34, v5
    v_mfma_f32_16x16x32_bf16 v[152:155], v[200:203], v[228:231], v[152:155]
    v_and_or_b32 v184, v95, s34, v5
    v_and_or_b32 v185, v29, s34, v5
    v_mfma_f32_16x16x32_bf16 v[168:171], v[200:203], v[232:235], v[168:171]
    v_and_or_b32 v186, v31, s34, v5
    v_and_or_b32 v187, v33, s34, v5
    s_waitcnt vmcnt(14)
    s_waitcnt lgkmcnt(0)
    v_mfma_f32_16x16x32_bf16 v[108:111], v[172:175], v[204:207], v[108:111]
    ds_read_b128 v[220:223], v3 offset:896
    v_lshrrev_b64 v[22:23], 4, v[96:97]
    v_mfma_f32_16x16x32_bf16 v[124:127], v[172:175], v[208:211], v[124:127]
    v_lshrrev_b64 v[24:25], 8, v[96:97]
    v_lshrrev_b64 v[26:27], 12, v[96:97]
    v_mfma_f32_16x16x32_bf16 v[140:143], v[172:175], v[212:215], v[140:143]
    ds_read_b128 v[224:227], v3 offset:19328
    v_and_or_b32 v188, v96, s34, v5
    v_mfma_f32_16x16x32_bf16 v[156:159], v[172:175], v[216:219], v[156:159]
    v_and_or_b32 v189, v22, s34, v5
    v_and_or_b32 v190, v24, s34, v5
    v_mfma_f32_16x16x32_bf16 v[112:115], v[176:179], v[204:207], v[112:115]
    ds_read_b128 v[228:231], v3 offset:37760
    v_and_or_b32 v191, v26, s34, v5
    v_mfma_f32_16x16x32_bf16 v[128:131], v[176:179], v[208:211], v[128:131]
    v_and_or_b32 v192, v97, s34, v5
    v_and_or_b32 v193, v23, s34, v5
    v_mfma_f32_16x16x32_bf16 v[144:147], v[176:179], v[212:215], v[144:147]
    ds_read_b128 v[232:235], v3 offset:56192
    v_and_or_b32 v194, v25, s34, v5
    v_mfma_f32_16x16x32_bf16 v[160:163], v[176:179], v[216:219], v[160:163]
    v_and_or_b32 v195, v27, s34, v5
    v_lshrrev_b64 v[28:29], 4, v[98:99]
    v_mfma_f32_16x16x32_bf16 v[116:119], v[180:183], v[204:207], v[116:119]
    buffer_load_dwordx2 v[60:61], v21, s[12:15], s92 offen
    v_mfma_f32_16x16x32_bf16 v[132:135], v[180:183], v[208:211], v[132:135]
    v_lshrrev_b64 v[30:31], 8, v[98:99]
    v_lshrrev_b64 v[32:33], 12, v[98:99]
    v_mfma_f32_16x16x32_bf16 v[148:151], v[180:183], v[212:215], v[148:151]
    buffer_load_dwordx2 v[62:63], v21, s[12:15], s93 offen
    v_mfma_f32_16x16x32_bf16 v[164:167], v[180:183], v[216:219], v[164:167]
    v_and_or_b32 v196, v98, s34, v5
    v_and_or_b32 v197, v28, s34, v5
    v_mfma_f32_16x16x32_bf16 v[120:123], v[184:187], v[204:207], v[120:123]
    buffer_load_dwordx2 v[64:65], v21, s[12:15], s94 offen
    v_mfma_f32_16x16x32_bf16 v[136:139], v[184:187], v[208:211], v[136:139]
    v_and_or_b32 v198, v30, s34, v5
    v_and_or_b32 v199, v32, s34, v5
    v_mfma_f32_16x16x32_bf16 v[152:155], v[184:187], v[212:215], v[152:155]
    v_and_or_b32 v200, v99, s34, v5
    v_and_or_b32 v201, v29, s34, v5
    v_mfma_f32_16x16x32_bf16 v[168:171], v[184:187], v[216:219], v[168:171]
    v_and_or_b32 v202, v31, s34, v5
    v_and_or_b32 v203, v33, s34, v5
    s_waitcnt vmcnt(16)
    s_waitcnt lgkmcnt(0)
    v_mfma_f32_16x16x32_bf16 v[108:111], v[188:191], v[220:223], v[108:111]
    ds_read_b128 v[204:207], v2 offset:1024
    v_lshrrev_b64 v[22:23], 4, v[100:101]
    v_mfma_f32_16x16x32_bf16 v[124:127], v[188:191], v[224:227], v[124:127]
    v_lshrrev_b64 v[24:25], 8, v[100:101]
    v_lshrrev_b64 v[26:27], 12, v[100:101]
    v_mfma_f32_16x16x32_bf16 v[140:143], v[188:191], v[228:231], v[140:143]
    ds_read_b128 v[208:211], v2 offset:19456
    v_and_or_b32 v172, v100, s34, v5
    v_mfma_f32_16x16x32_bf16 v[156:159], v[188:191], v[232:235], v[156:159]
    v_and_or_b32 v173, v22, s34, v5
    v_and_or_b32 v174, v24, s34, v5
    v_mfma_f32_16x16x32_bf16 v[112:115], v[192:195], v[220:223], v[112:115]
    ds_read_b128 v[212:215], v2 offset:37888
    v_and_or_b32 v175, v26, s34, v5
    v_mfma_f32_16x16x32_bf16 v[128:131], v[192:195], v[224:227], v[128:131]
    v_and_or_b32 v176, v101, s34, v5
    v_and_or_b32 v177, v23, s34, v5
    v_mfma_f32_16x16x32_bf16 v[144:147], v[192:195], v[228:231], v[144:147]
    ds_read_b128 v[216:219], v2 offset:56320
    v_and_or_b32 v178, v25, s34, v5
    v_mfma_f32_16x16x32_bf16 v[160:163], v[192:195], v[232:235], v[160:163]
    v_and_or_b32 v179, v27, s34, v5
    v_lshrrev_b64 v[28:29], 4, v[102:103]
    v_mfma_f32_16x16x32_bf16 v[116:119], v[196:199], v[220:223], v[116:119]
    buffer_load_dwordx2 v[66:67], v21, s[12:15], s95 offen
    v_mfma_f32_16x16x32_bf16 v[132:135], v[196:199], v[224:227], v[132:135]
    v_lshrrev_b64 v[30:31], 8, v[102:103]
    v_lshrrev_b64 v[32:33], 12, v[102:103]
    v_mfma_f32_16x16x32_bf16 v[148:151], v[196:199], v[228:231], v[148:151]
    buffer_load_dwordx2 v[68:69], v21, s[12:15], s96 offen
    v_mfma_f32_16x16x32_bf16 v[164:167], v[196:199], v[232:235], v[164:167]
    v_and_or_b32 v180, v102, s34, v5
    v_and_or_b32 v181, v28, s34, v5
    v_mfma_f32_16x16x32_bf16 v[120:123], v[200:203], v[220:223], v[120:123]
    buffer_load_dwordx2 v[70:71], v21, s[12:15], s97 offen
    v_mfma_f32_16x16x32_bf16 v[136:139], v[200:203], v[224:227], v[136:139]
    v_and_or_b32 v182, v30, s34, v5
    v_and_or_b32 v183, v32, s34, v5
    v_mfma_f32_16x16x32_bf16 v[152:155], v[200:203], v[228:231], v[152:155]
    v_and_or_b32 v184, v103, s34, v5
    v_and_or_b32 v185, v29, s34, v5
    v_mfma_f32_16x16x32_bf16 v[168:171], v[200:203], v[232:235], v[168:171]
    v_and_or_b32 v186, v31, s34, v5
    v_and_or_b32 v187, v33, s34, v5
    s_waitcnt vmcnt(15)
    s_waitcnt lgkmcnt(0)
    v_mfma_f32_16x16x32_bf16 v[108:111], v[172:175], v[204:207], v[108:111]
    ds_read_b128 v[220:223], v3 offset:1024
    v_lshrrev_b64 v[22:23], 4, v[104:105]
    v_mfma_f32_16x16x32_bf16 v[124:127], v[172:175], v[208:211], v[124:127]
    v_lshrrev_b64 v[24:25], 8, v[104:105]
    v_lshrrev_b64 v[26:27], 12, v[104:105]
    v_mfma_f32_16x16x32_bf16 v[140:143], v[172:175], v[212:215], v[140:143]
    ds_read_b128 v[224:227], v3 offset:19456
    v_and_or_b32 v188, v104, s34, v5
    v_mfma_f32_16x16x32_bf16 v[156:159], v[172:175], v[216:219], v[156:159]
    v_and_or_b32 v189, v22, s34, v5
    v_and_or_b32 v190, v24, s34, v5
    v_mfma_f32_16x16x32_bf16 v[112:115], v[176:179], v[204:207], v[112:115]
    ds_read_b128 v[228:231], v3 offset:37888
    v_and_or_b32 v191, v26, s34, v5
    v_mfma_f32_16x16x32_bf16 v[128:131], v[176:179], v[208:211], v[128:131]
    v_and_or_b32 v192, v105, s34, v5
    v_and_or_b32 v193, v23, s34, v5
    v_mfma_f32_16x16x32_bf16 v[144:147], v[176:179], v[212:215], v[144:147]
    ds_read_b128 v[232:235], v3 offset:56320
    v_and_or_b32 v194, v25, s34, v5
    v_mfma_f32_16x16x32_bf16 v[160:163], v[176:179], v[216:219], v[160:163]
    v_and_or_b32 v195, v27, s34, v5
    v_lshrrev_b64 v[28:29], 4, v[106:107]
    v_mfma_f32_16x16x32_bf16 v[116:119], v[180:183], v[204:207], v[116:119]
    v_lshrrev_b64 v[30:31], 8, v[106:107]
    v_lshrrev_b64 v[32:33], 12, v[106:107]
    v_mfma_f32_16x16x32_bf16 v[132:135], v[180:183], v[208:211], v[132:135]
    v_and_or_b32 v196, v106, s34, v5
    v_and_or_b32 v197, v28, s34, v5
    v_mfma_f32_16x16x32_bf16 v[148:151], v[180:183], v[212:215], v[148:151]
    v_and_or_b32 v198, v30, s34, v5
    v_and_or_b32 v199, v32, s34, v5
    v_mfma_f32_16x16x32_bf16 v[164:167], v[180:183], v[216:219], v[164:167]
    v_and_or_b32 v200, v107, s34, v5
    v_and_or_b32 v201, v29, s34, v5
    v_mfma_f32_16x16x32_bf16 v[120:123], v[184:187], v[204:207], v[120:123]
    v_and_or_b32 v202, v31, s34, v5
    v_and_or_b32 v203, v33, s34, v5
    v_mfma_f32_16x16x32_bf16 v[136:139], v[184:187], v[208:211], v[136:139]
    v_mfma_f32_16x16x32_bf16 v[152:155], v[184:187], v[212:215], v[152:155]
    v_mfma_f32_16x16x32_bf16 v[168:171], v[184:187], v[216:219], v[168:171]
    s_waitcnt lgkmcnt(0)
    s_nop 0
    v_mfma_f32_16x16x32_bf16 v[108:111], v[188:191], v[220:223], v[108:111]
    ds_read_b128 v[72:75], v14 offset:0
    v_mfma_f32_16x16x32_bf16 v[124:127], v[188:191], v[224:227], v[124:127]
    ds_read_b128 v[76:79], v14 offset:16
    v_mfma_f32_16x16x32_bf16 v[140:143], v[188:191], v[228:231], v[140:143]
    ds_read_b128 v[80:83], v14 offset:32
    v_mfma_f32_16x16x32_bf16 v[156:159], v[188:191], v[232:235], v[156:159]
    ds_read_b128 v[84:87], v14 offset:48
    v_mfma_f32_16x16x32_bf16 v[112:115], v[192:195], v[220:223], v[112:115]
    ds_read_b128 v[88:91], v14 offset:2304
    v_mfma_f32_16x16x32_bf16 v[128:131], v[192:195], v[224:227], v[128:131]
    ds_read_b128 v[92:95], v14 offset:2320
    v_mfma_f32_16x16x32_bf16 v[144:147], v[192:195], v[228:231], v[144:147]
    ds_read_b128 v[96:99], v14 offset:2336
    v_mfma_f32_16x16x32_bf16 v[160:163], v[192:195], v[232:235], v[160:163]
    ds_read_b128 v[100:103], v14 offset:2352
    v_mfma_f32_16x16x32_bf16 v[116:119], v[196:199], v[220:223], v[116:119]
    ds_read_b32 v6, v19 offset:0
    v_mfma_f32_16x16x32_bf16 v[132:135], v[196:199], v[224:227], v[132:135]
    ds_read_b32 v7, v19 offset:64
    v_mfma_f32_16x16x32_bf16 v[148:151], v[196:199], v[228:231], v[148:151]
    ds_read_b32 v8, v19 offset:128
    v_mfma_f32_16x16x32_bf16 v[164:167], v[196:199], v[232:235], v[164:167]
    ds_read_b32 v9, v19 offset:192
    v_mfma_f32_16x16x32_bf16 v[120:123], v[200:203], v[220:223], v[120:123]
    v_mfma_f32_16x16x32_bf16 v[136:139], v[200:203], v[224:227], v[136:139]
    v_mfma_f32_16x16x32_bf16 v[152:155], v[200:203], v[228:231], v[152:155]
    v_mfma_f32_16x16x32_bf16 v[168:171], v[200:203], v[232:235], v[168:171]
    s_setprio 0
    s_nop 7
    s_waitcnt lgkmcnt(0)
    v_fma_f32 v108, -v88, v6, v108
    v_fma_f32 v112, -v89, v6, v112
    v_fma_f32 v116, -v90, v6, v116
    v_fma_f32 v120, -v91, v6, v120
    v_fma_f32 v109, -v92, v6, v109
    v_fma_f32 v113, -v93, v6, v113
    v_fma_f32 v117, -v94, v6, v117
    v_fma_f32 v121, -v95, v6, v121
    v_fma_f32 v110, -v96, v6, v110
    v_fma_f32 v114, -v97, v6, v114
    v_fma_f32 v118, -v98, v6, v118
    v_fma_f32 v122, -v99, v6, v122
    v_fma_f32 v111, -v100, v6, v111
    v_fma_f32 v115, -v101, v6, v115
    v_fma_f32 v119, -v102, v6, v119
    v_fma_f32 v123, -v103, v6, v123
    v_mul_f32 v108, v108, v72
    v_mul_f32 v112, v112, v73
    v_mul_f32 v116, v116, v74
    v_mul_f32 v120, v120, v75
    v_mul_f32 v109, v109, v76
    v_mul_f32 v113, v113, v77
    v_mul_f32 v117, v117, v78
    v_mul_f32 v121, v121, v79
    v_mul_f32 v110, v110, v80
    v_mul_f32 v114, v114, v81
    v_mul_f32 v118, v118, v82
    v_mul_f32 v122, v122, v83
    v_mul_f32 v111, v111, v84
    v_mul_f32 v115, v115, v85
    v_mul_f32 v119, v119, v86
    v_mul_f32 v123, v123, v87
    v_cvt_pk_bf16_f32 v236, v108, v112
    v_cvt_pk_bf16_f32 v237, v116, v120
    v_cvt_pk_bf16_f32 v238, v109, v113
    v_cvt_pk_bf16_f32 v239, v117, v121
    v_cvt_pk_bf16_f32 v240, v110, v114
    v_cvt_pk_bf16_f32 v241, v118, v122
    v_cvt_pk_bf16_f32 v242, v111, v115
    v_cvt_pk_bf16_f32 v243, v119, v123
    ds_write_b128 v10, v[236:239] offset:0
    ds_write_b128 v11, v[240:243] offset:0
    ds_read_b128 v[204:207], v12 offset:0
    ds_read_b128 v[208:211], v12 offset:1024
    v_fma_f32 v124, -v88, v7, v124
    v_fma_f32 v128, -v89, v7, v128
    v_fma_f32 v132, -v90, v7, v132
    v_fma_f32 v136, -v91, v7, v136
    v_fma_f32 v125, -v92, v7, v125
    v_fma_f32 v129, -v93, v7, v129
    v_fma_f32 v133, -v94, v7, v133
    v_fma_f32 v137, -v95, v7, v137
    v_fma_f32 v126, -v96, v7, v126
    v_fma_f32 v130, -v97, v7, v130
    v_fma_f32 v134, -v98, v7, v134
    v_fma_f32 v138, -v99, v7, v138
    v_fma_f32 v127, -v100, v7, v127
    v_fma_f32 v131, -v101, v7, v131
    v_fma_f32 v135, -v102, v7, v135
    v_fma_f32 v139, -v103, v7, v139
    v_mul_f32 v124, v124, v72
    v_mul_f32 v128, v128, v73
    v_mul_f32 v132, v132, v74
    v_mul_f32 v136, v136, v75
    v_mul_f32 v125, v125, v76
    v_mul_f32 v129, v129, v77
    v_mul_f32 v133, v133, v78
    v_mul_f32 v137, v137, v79
    v_mul_f32 v126, v126, v80
    v_mul_f32 v130, v130, v81
    v_mul_f32 v134, v134, v82
    v_mul_f32 v138, v138, v83
    v_mul_f32 v127, v127, v84
    v_mul_f32 v131, v131, v85
    v_mul_f32 v135, v135, v86
    v_mul_f32 v139, v139, v87
    v_cvt_pk_bf16_f32 v244, v124, v128
    v_cvt_pk_bf16_f32 v245, v132, v136
    v_cvt_pk_bf16_f32 v246, v125, v129
    v_cvt_pk_bf16_f32 v247, v133, v137
    v_cvt_pk_bf16_f32 v248, v126, v130
    v_cvt_pk_bf16_f32 v249, v134, v138
    v_cvt_pk_bf16_f32 v250, v127, v131
    v_cvt_pk_bf16_f32 v251, v135, v139
    ds_write_b128 v10, v[244:247] offset:2048
    ds_write_b128 v11, v[248:251] offset:2048
    ds_read_b128 v[212:215], v12 offset:2048
    ds_read_b128 v[216:219], v12 offset:3072
    s_waitcnt lgkmcnt(4)
    buffer_store_dwordx4 v[204:207], v13, s[24:27], s52 offen sc1 nt
    buffer_store_dwordx4 v[208:211], v13, s[24:27], s53 offen sc1 nt
    v_fma_f32 v140, -v88, v8, v140
    v_fma_f32 v144, -v89, v8, v144
    v_fma_f32 v148, -v90, v8, v148
    v_fma_f32 v152, -v91, v8, v152
    v_fma_f32 v141, -v92, v8, v141
    v_fma_f32 v145, -v93, v8, v145
    v_fma_f32 v149, -v94, v8, v149
    v_fma_f32 v153, -v95, v8, v153
    v_fma_f32 v142, -v96, v8, v142
    v_fma_f32 v146, -v97, v8, v146
    v_fma_f32 v150, -v98, v8, v150
    v_fma_f32 v154, -v99, v8, v154
    v_fma_f32 v143, -v100, v8, v143
    v_fma_f32 v147, -v101, v8, v147
    v_fma_f32 v151, -v102, v8, v151
    v_fma_f32 v155, -v103, v8, v155
    v_mul_f32 v140, v140, v72
    v_mul_f32 v144, v144, v73
    v_mul_f32 v148, v148, v74
    v_mul_f32 v152, v152, v75
    v_mul_f32 v141, v141, v76
    v_mul_f32 v145, v145, v77
    v_mul_f32 v149, v149, v78
    v_mul_f32 v153, v153, v79
    v_mul_f32 v142, v142, v80
    v_mul_f32 v146, v146, v81
    v_mul_f32 v150, v150, v82
    v_mul_f32 v154, v154, v83
    v_mul_f32 v143, v143, v84
    v_mul_f32 v147, v147, v85
    v_mul_f32 v151, v151, v86
    v_mul_f32 v155, v155, v87
    v_cvt_pk_bf16_f32 v236, v140, v144
    v_cvt_pk_bf16_f32 v237, v148, v152
    v_cvt_pk_bf16_f32 v238, v141, v145
    v_cvt_pk_bf16_f32 v239, v149, v153
    v_cvt_pk_bf16_f32 v240, v142, v146
    v_cvt_pk_bf16_f32 v241, v150, v154
    v_cvt_pk_bf16_f32 v242, v143, v147
    v_cvt_pk_bf16_f32 v243, v151, v155
    ds_write_b128 v10, v[236:239] offset:0
    ds_write_b128 v11, v[240:243] offset:0
    ds_read_b128 v[220:223], v12 offset:0
    ds_read_b128 v[224:227], v12 offset:1024
    s_waitcnt lgkmcnt(4)
    buffer_store_dwordx4 v[212:215], v13, s[24:27], s54 offen sc1 nt
    buffer_store_dwordx4 v[216:219], v13, s[24:27], s55 offen sc1 nt
    v_fma_f32 v156, -v88, v9, v156
    v_fma_f32 v160, -v89, v9, v160
    v_fma_f32 v164, -v90, v9, v164
    v_fma_f32 v168, -v91, v9, v168
    v_fma_f32 v157, -v92, v9, v157
    v_fma_f32 v161, -v93, v9, v161
    v_fma_f32 v165, -v94, v9, v165
    v_fma_f32 v169, -v95, v9, v169
    v_fma_f32 v158, -v96, v9, v158
    v_fma_f32 v162, -v97, v9, v162
    v_fma_f32 v166, -v98, v9, v166
    v_fma_f32 v170, -v99, v9, v170
    v_fma_f32 v159, -v100, v9, v159
    v_fma_f32 v163, -v101, v9, v163
    v_fma_f32 v167, -v102, v9, v167
    v_fma_f32 v171, -v103, v9, v171
    v_mul_f32 v156, v156, v72
    v_mul_f32 v160, v160, v73
    v_mul_f32 v164, v164, v74
    v_mul_f32 v168, v168, v75
    v_mul_f32 v157, v157, v76
    v_mul_f32 v161, v161, v77
    v_mul_f32 v165, v165, v78
    v_mul_f32 v169, v169, v79
    v_mul_f32 v158, v158, v80
    v_mul_f32 v162, v162, v81
    v_mul_f32 v166, v166, v82
    v_mul_f32 v170, v170, v83
    v_mul_f32 v159, v159, v84
    v_mul_f32 v163, v163, v85
    v_mul_f32 v167, v167, v86
    v_mul_f32 v171, v171, v87
    v_cvt_pk_bf16_f32 v244, v156, v160
    v_cvt_pk_bf16_f32 v245, v164, v168
    v_cvt_pk_bf16_f32 v246, v157, v161
    v_cvt_pk_bf16_f32 v247, v165, v169
    v_cvt_pk_bf16_f32 v248, v158, v162
    v_cvt_pk_bf16_f32 v249, v166, v170
    v_cvt_pk_bf16_f32 v250, v159, v163
    v_cvt_pk_bf16_f32 v251, v167, v171
    ds_write_b128 v10, v[244:247] offset:2048
    ds_write_b128 v11, v[248:251] offset:2048
    ds_read_b128 v[228:231], v12 offset:2048
    ds_read_b128 v[232:235], v12 offset:3072
    s_waitcnt lgkmcnt(4)
    buffer_store_dwordx4 v[220:223], v13, s[24:27], s56 offen sc1 nt
    buffer_store_dwordx4 v[224:227], v13, s[24:27], s57 offen sc1 nt
    s_waitcnt lgkmcnt(1)
    buffer_store_dwordx4 v[228:231], v13, s[24:27], s58 offen sc1 nt
    s_waitcnt lgkmcnt(0)
    buffer_store_dwordx4 v[232:235], v13, s[24:27], s59 offen sc1 nt
    s_setprio 0
    s_and_b32 s42, s29, 1
    s_mul_i32 s43, s42, 36864
    v_add_u32 v2, s43, v2
    v_add_u32 v3, s43, v3
    s_lshl_b32 s43, s42, 7
    v_add_u32 v19, s43, v19
    ds_read_b128 v[204:207], v2 offset:0
    ds_read_b128 v[208:211], v2 offset:18432
    ds_read_b128 v[212:215], v3 offset:0
    ds_read_b128 v[216:219], v3 offset:18432
    ds_read_b128 v[220:223], v2 offset:128
    ds_read_b128 v[224:227], v2 offset:18560
    s_lshr_b32 s41, s29, 1
    s_lshl_b32 s43, s41, 7
    s_add_u32 s43, s43, 75776
    v_lshl_add_u32 v14, v17, 5, s43
    s_lshl_b32 s41, s41, 6
    s_add_u32 s52, s33, s41
    s_mul_i32 s41, s42, 294912
    s_add_u32 s52, s52, s41
    s_add_u32 s52, s52, 1024
    s_add_u32 s53, s52, 147456
    s_lshl_b32 s42, s28, 12
    s_add_u32 s42, s42, 78848
    v_bfe_u32 v1, v16, 1, 2
    v_xor_b32 v1, v1, v17
    v_lshlrev_b32 v1, 4, v1
    v_lshl_add_u32 v1, v16, 6, v1
    v_add_u32 v10, s42, v1
    v_lshrrev_b32 v1, 2, v15
    v_and_b32 v18, 3, v15
    v_bfe_u32 v12, v1, 1, 2
    v_xor_b32 v12, v12, v18
    v_lshlrev_b32 v12, 4, v12
    v_lshl_add_u32 v12, v1, 6, v12
    v_add_u32 v12, s42, v12
    v_mul_u32_u24 v13, 9216, v1
    v_lshl_add_u32 v13, v18, 4, v13
    s_waitcnt vmcnt(8)
    v_lshrrev_b64 v[22:23], 4, v[36:37]
    v_lshrrev_b64 v[24:25], 8, v[36:37]
    v_lshrrev_b64 v[26:27], 12, v[36:37]
    v_and_or_b32 v172, v36, s34, v5
    v_and_or_b32 v173, v22, s34, v5
    v_and_or_b32 v174, v24, s34, v5
    v_and_or_b32 v175, v26, s34, v5
    v_and_or_b32 v176, v37, s34, v5
    v_and_or_b32 v177, v23, s34, v5
    v_and_or_b32 v178, v25, s34, v5
    v_and_or_b32 v179, v27, s34, v5
.p2align 3
    s_waitcnt lgkmcnt(4)
    s_nop 0
    v_mfma_f32_16x16x32_bf16 v[108:111], v[172:175], v[204:207], 0
    ds_read_b128 v[228:231], v3 offset:128
    v_lshrrev_b64 v[22:23], 4, v[38:39]
    v_lshrrev_b64 v[24:25], 8, v[38:39]
    v_lshrrev_b64 v[26:27], 12, v[38:39]
    v_mfma_f32_16x16x32_bf16 v[124:127], v[172:175], v[208:211], 0
    v_and_or_b32 v188, v38, s34, v5
    v_and_or_b32 v189, v22, s34, v5
    v_and_or_b32 v190, v24, s34, v5
    v_and_or_b32 v191, v26, s34, v5
    v_mfma_f32_16x16x32_bf16 v[112:115], v[176:179], v[204:207], 0
    ds_read_b128 v[232:235], v3 offset:18560
    v_and_or_b32 v192, v39, s34, v5
    v_and_or_b32 v193, v23, s34, v5
    v_and_or_b32 v194, v25, s34, v5
    v_mfma_f32_16x16x32_bf16 v[128:131], v[176:179], v[208:211], 0
    v_and_or_b32 v195, v27, s34, v5
    s_waitcnt lgkmcnt(4)
    s_nop 0
    v_mfma_f32_16x16x32_bf16 v[108:111], v[188:191], v[212:215], v[108:111]
    ds_read_b128 v[204:207], v2 offset:256
    v_lshrrev_b64 v[22:23], 4, v[40:41]
    v_lshrrev_b64 v[24:25], 8, v[40:41]
    v_lshrrev_b64 v[26:27], 12, v[40:41]
    v_mfma_f32_16x16x32_bf16 v[124:127], v[188:191], v[216:219], v[124:127]
    v_and_or_b32 v172, v40, s34, v5
    v_and_or_b32 v173, v22, s34, v5
    v_and_or_b32 v174, v24, s34, v5
    v_and_or_b32 v175, v26, s34, v5
    v_mfma_f32_16x16x32_bf16 v[112:115], v[192:195], v[212:215], v[112:115]
    ds_read_b128 v[208:211], v2 offset:18688
    v_and_or_b32 v176, v41, s34, v5
    v_and_or_b32 v177, v23, s34, v5
    v_and_or_b32 v178, v25, s34, v5
    v_mfma_f32_16x16x32_bf16 v[128:131], v[192:195], v[216:219], v[128:131]
    v_and_or_b32 v179, v27, s34, v5
    s_waitcnt lgkmcnt(4)
    s_nop 0
    v_mfma_f32_16x16x32_bf16 v[108:111], v[172:175], v[220:223], v[108:111]
    ds_read_b128 v[212:215], v3 offset:256
    v_lshrrev_b64 v[22:23], 4, v[42:43]
    v_lshrrev_b64 v[24:25], 8, v[42:43]
    v_lshrrev_b64 v[26:27], 12, v[42:43]
    v_mfma_f32_16x16x32_bf16 v[124:127], v[172:175], v[224:227], v[124:127]
    v_and_or_b32 v188, v42, s34, v5
    v_and_or_b32 v189, v22, s34, v5
    v_and_or_b32 v190, v24, s34, v5
    v_and_or_b32 v191, v26, s34, v5
    v_mfma_f32_16x16x32_bf16 v[112:115], v[176:179], v[220:223], v[112:115]
    ds_read_b128 v[216:219], v3 offset:18688
    v_and_or_b32 v192, v43, s34, v5
    v_and_or_b32 v193, v23, s34, v5
    v_and_or_b32 v194, v25, s34, v5
    v_mfma_f32_16x16x32_bf16 v[128:131], v[176:179], v[224:227], v[128:131]
    v_and_or_b32 v195, v27, s34, v5
    s_waitcnt lgkmcnt(4)
    s_nop 0
    v_mfma_f32_16x16x32_bf16 v[108:111], v[188:191], v[228:231], v[108:111]
    ds_read_b128 v[220:223], v2 offset:384
    v_lshrrev_b64 v[22:23], 4, v[44:45]
    v_lshrrev_b64 v[24:25], 8, v[44:45]
    v_lshrrev_b64 v[26:27], 12, v[44:45]
    v_mfma_f32_16x16x32_bf16 v[124:127], v[188:191], v[232:235], v[124:127]
    v_and_or_b32 v172, v44, s34, v5
    v_and_or_b32 v173, v22, s34, v5
    v_and_or_b32 v174, v24, s34, v5
    v_and_or_b32 v175, v26, s34, v5
    v_mfma_f32_16x16x32_bf16 v[112:115], v[192:195], v[228:231], v[112:115]
    ds_read_b128 v[224:227], v2 offset:18816
    v_and_or_b32 v176, v45, s34, v5
    v_and_or_b32 v177, v23, s34, v5
    v_and_or_b32 v178, v25, s34, v5
    v_mfma_f32_16x16x32_bf16 v[128:131], v[192:195], v[232:235], v[128:131]
    v_and_or_b32 v179, v27, s34, v5
    s_waitcnt lgkmcnt(4)
    s_nop 0
    v_mfma_f32_16x16x32_bf16 v[108:111], v[172:175], v[204:207], v[108:111]
    ds_read_b128 v[228:231], v3 offset:384
    v_lshrrev_b64 v[22:23], 4, v[46:47]
    v_lshrrev_b64 v[24:25], 8, v[46:47]
    v_lshrrev_b64 v[26:27], 12, v[46:47]
    v_mfma_f32_16x16x32_bf16 v[124:127], v[172:175], v[208:211], v[124:127]
    v_and_or_b32 v188, v46, s34, v5
    v_and_or_b32 v189, v22, s34, v5
    v_and_or_b32 v190, v24, s34, v5
    v_and_or_b32 v191, v26, s34, v5
    v_mfma_f32_16x16x32_bf16 v[112:115], v[176:179], v[204:207], v[112:115]
    ds_read_b128 v[232:235], v3 offset:18816
    v_and_or_b32 v192, v47, s34, v5
    v_and_or_b32 v193, v23, s34, v5
    v_and_or_b32 v194, v25, s34, v5
    v_mfma_f32_16x16x32_bf16 v[128:131], v[176:179], v[208:211], v[128:131]
    v_and_or_b32 v195, v27, s34, v5
    s_waitcnt lgkmcnt(4)
    s_nop 0
    v_mfma_f32_16x16x32_bf16 v[108:111], v[188:191], v[212:215], v[108:111]
    ds_read_b128 v[204:207], v2 offset:512
    v_lshrrev_b64 v[22:23], 4, v[48:49]
    v_lshrrev_b64 v[24:25], 8, v[48:49]
    v_lshrrev_b64 v[26:27], 12, v[48:49]
    v_mfma_f32_16x16x32_bf16 v[124:127], v[188:191], v[216:219], v[124:127]
    v_and_or_b32 v172, v48, s34, v5
    v_and_or_b32 v173, v22, s34, v5
    v_and_or_b32 v174, v24, s34, v5
    v_and_or_b32 v175, v26, s34, v5
    v_mfma_f32_16x16x32_bf16 v[112:115], v[192:195], v[212:215], v[112:115]
    ds_read_b128 v[208:211], v2 offset:18944
    v_and_or_b32 v176, v49, s34, v5
    v_and_or_b32 v177, v23, s34, v5
    v_and_or_b32 v178, v25, s34, v5
    v_mfma_f32_16x16x32_bf16 v[128:131], v[192:195], v[216:219], v[128:131]
    v_and_or_b32 v179, v27, s34, v5
    s_waitcnt lgkmcnt(4)
    s_nop 0
    v_mfma_f32_16x16x32_bf16 v[108:111], v[172:175], v[220:223], v[108:111]
    ds_read_b128 v[212:215], v3 offset:512
    v_lshrrev_b64 v[22:23], 4, v[50:51]
    v_lshrrev_b64 v[24:25], 8, v[50:51]
    v_lshrrev_b64 v[26:27], 12, v[50:51]
    v_mfma_f32_16x16x32_bf16 v[124:127], v[172:175], v[224:227], v[124:127]
    v_and_or_b32 v188, v50, s34, v5
    v_and_or_b32 v189, v22, s34, v5
    v_and_or_b32 v190, v24, s34, v5
    v_and_or_b32 v191, v26, s34, v5
    v_mfma_f32_16x16x32_bf16 v[112:115], v[176:179], v[220:223], v[112:115]
    ds_read_b128 v[216:219], v3 offset:18944
    v_and_or_b32 v192, v51, s34, v5
    v_and_or_b32 v193, v23, s34, v5
    v_and_or_b32 v194, v25, s34, v5
    v_mfma_f32_16x16x32_bf16 v[128:131], v[176:179], v[224:227], v[128:131]
    v_and_or_b32 v195, v27, s34, v5
    s_waitcnt lgkmcnt(4)
    s_nop 0
    v_mfma_f32_16x16x32_bf16 v[108:111], v[188:191], v[228:231], v[108:111]
    ds_read_b128 v[220:223], v2 offset:640
    v_lshrrev_b64 v[22:23], 4, v[52:53]
    v_lshrrev_b64 v[24:25], 8, v[52:53]
    v_lshrrev_b64 v[26:27], 12, v[52:53]
    v_mfma_f32_16x16x32_bf16 v[124:127], v[188:191], v[232:235], v[124:127]
    v_and_or_b32 v172, v52, s34, v5
    v_and_or_b32 v173, v22, s34, v5
    v_and_or_b32 v174, v24, s34, v5
    v_and_or_b32 v175, v26, s34, v5
    v_mfma_f32_16x16x32_bf16 v[112:115], v[192:195], v[228:231], v[112:115]
    ds_read_b128 v[224:227], v2 offset:19072
    v_and_or_b32 v176, v53, s34, v5
    v_and_or_b32 v177, v23, s34, v5
    v_and_or_b32 v178, v25, s34, v5
    v_mfma_f32_16x16x32_bf16 v[128:131], v[192:195], v[232:235], v[128:131]
    v_and_or_b32 v179, v27, s34, v5
    s_waitcnt lgkmcnt(4)
    s_nop 0
    v_mfma_f32_16x16x32_bf16 v[108:111], v[172:175], v[204:207], v[108:111]
    ds_read_b128 v[228:231], v3 offset:640
    v_lshrrev_b64 v[22:23], 4, v[54:55]
    v_lshrrev_b64 v[24:25], 8, v[54:55]
    v_lshrrev_b64 v[26:27], 12, v[54:55]
    v_mfma_f32_16x16x32_bf16 v[124:127], v[172:175], v[208:211], v[124:127]
    v_and_or_b32 v188, v54, s34, v5
    v_and_or_b32 v189, v22, s34, v5
    v_and_or_b32 v190, v24, s34, v5
    v_and_or_b32 v191, v26, s34, v5
    v_mfma_f32_16x16x32_bf16 v[112:115], v[176:179], v[204:207], v[112:115]
    ds_read_b128 v[232:235], v3 offset:19072
    v_and_or_b32 v192, v55, s34, v5
    v_and_or_b32 v193, v23, s34, v5
    v_and_or_b32 v194, v25, s34, v5
    v_mfma_f32_16x16x32_bf16 v[128:131], v[176:179], v[208:211], v[128:131]
    v_and_or_b32 v195, v27, s34, v5
    s_waitcnt lgkmcnt(4)
    s_nop 0
    v_mfma_f32_16x16x32_bf16 v[108:111], v[188:191], v[212:215], v[108:111]
    ds_read_b128 v[204:207], v2 offset:768
    v_lshrrev_b64 v[22:23], 4, v[56:57]
    v_lshrrev_b64 v[24:25], 8, v[56:57]
    v_lshrrev_b64 v[26:27], 12, v[56:57]
    v_mfma_f32_16x16x32_bf16 v[124:127], v[188:191], v[216:219], v[124:127]
    v_and_or_b32 v172, v56, s34, v5
    v_and_or_b32 v173, v22, s34, v5
    v_and_or_b32 v174, v24, s34, v5
    v_and_or_b32 v175, v26, s34, v5
    v_mfma_f32_16x16x32_bf16 v[112:115], v[192:195], v[212:215], v[112:115]
    ds_read_b128 v[208:211], v2 offset:19200
    v_and_or_b32 v176, v57, s34, v5
    v_and_or_b32 v177, v23, s34, v5
    v_and_or_b32 v178, v25, s34, v5
    v_mfma_f32_16x16x32_bf16 v[128:131], v[192:195], v[216:219], v[128:131]
    v_and_or_b32 v179, v27, s34, v5
    s_waitcnt lgkmcnt(4)
    s_nop 0
    v_mfma_f32_16x16x32_bf16 v[108:111], v[172:175], v[220:223], v[108:111]
    ds_read_b128 v[212:215], v3 offset:768
    v_lshrrev_b64 v[22:23], 4, v[58:59]
    v_lshrrev_b64 v[24:25], 8, v[58:59]
    v_lshrrev_b64 v[26:27], 12, v[58:59]
    v_mfma_f32_16x16x32_bf16 v[124:127], v[172:175], v[224:227], v[124:127]
    v_and_or_b32 v188, v58, s34, v5
    v_and_or_b32 v189, v22, s34, v5
    v_and_or_b32 v190, v24, s34, v5
    v_and_or_b32 v191, v26, s34, v5
    v_mfma_f32_16x16x32_bf16 v[112:115], v[176:179], v[220:223], v[112:115]
    ds_read_b128 v[216:219], v3 offset:19200
    v_and_or_b32 v192, v59, s34, v5
    v_and_or_b32 v193, v23, s34, v5
    v_and_or_b32 v194, v25, s34, v5
    v_mfma_f32_16x16x32_bf16 v[128:131], v[176:179], v[224:227], v[128:131]
    v_and_or_b32 v195, v27, s34, v5
    s_waitcnt lgkmcnt(4)
    s_nop 0
    v_mfma_f32_16x16x32_bf16 v[108:111], v[188:191], v[228:231], v[108:111]
    ds_read_b128 v[220:223], v2 offset:896
    v_lshrrev_b64 v[22:23], 4, v[60:61]
    v_lshrrev_b64 v[24:25], 8, v[60:61]
    v_lshrrev_b64 v[26:27], 12, v[60:61]
    v_mfma_f32_16x16x32_bf16 v[124:127], v[188:191], v[232:235], v[124:127]
    v_and_or_b32 v172, v60, s34, v5
    v_and_or_b32 v173, v22, s34, v5
    v_and_or_b32 v174, v24, s34, v5
    v_and_or_b32 v175, v26, s34, v5
    v_mfma_f32_16x16x32_bf16 v[112:115], v[192:195], v[228:231], v[112:115]
    ds_read_b128 v[224:227], v2 offset:19328
    v_and_or_b32 v176, v61, s34, v5
    v_and_or_b32 v177, v23, s34, v5
    v_and_or_b32 v178, v25, s34, v5
    v_mfma_f32_16x16x32_bf16 v[128:131], v[192:195], v[232:235], v[128:131]
    v_and_or_b32 v179, v27, s34, v5
    s_waitcnt lgkmcnt(4)
    s_nop 0
    v_mfma_f32_16x16x32_bf16 v[108:111], v[172:175], v[204:207], v[108:111]
    ds_read_b128 v[228:231], v3 offset:896
    v_lshrrev_b64 v[22:23], 4, v[62:63]
    v_lshrrev_b64 v[24:25], 8, v[62:63]
    v_lshrrev_b64 v[26:27], 12, v[62:63]
    v_mfma_f32_16x16x32_bf16 v[124:127], v[172:175], v[208:211], v[124:127]
    v_and_or_b32 v188, v62, s34, v5
    v_and_or_b32 v189, v22, s34, v5
    v_and_or_b32 v190, v24, s34, v5
    v_and_or_b32 v191, v26, s34, v5
    v_mfma_f32_16x16x32_bf16 v[112:115], v[176:179], v[204:207], v[112:115]
    ds_read_b128 v[232:235], v3 offset:19328
    v_and_or_b32 v192, v63, s34, v5
    v_and_or_b32 v193, v23, s34, v5
    v_and_or_b32 v194, v25, s34, v5
    v_mfma_f32_16x16x32_bf16 v[128:131], v[176:179], v[208:211], v[128:131]
    v_and_or_b32 v195, v27, s34, v5
    s_waitcnt lgkmcnt(4)
    s_nop 0
    v_mfma_f32_16x16x32_bf16 v[108:111], v[188:191], v[212:215], v[108:111]
    ds_read_b128 v[204:207], v2 offset:1024
    v_lshrrev_b64 v[22:23], 4, v[64:65]
    v_lshrrev_b64 v[24:25], 8, v[64:65]
    v_lshrrev_b64 v[26:27], 12, v[64:65]
    v_mfma_f32_16x16x32_bf16 v[124:127], v[188:191], v[216:219], v[124:127]
    v_and_or_b32 v172, v64, s34, v5
    v_and_or_b32 v173, v22, s34, v5
    v_and_or_b32 v174, v24, s34, v5
    v_and_or_b32 v175, v26, s34, v5
    v_mfma_f32_16x16x32_bf16 v[112:115], v[192:195], v[212:215], v[112:115]
    ds_read_b128 v[208:211], v2 offset:19456
    v_and_or_b32 v176, v65, s34, v5
    v_and_or_b32 v177, v23, s34, v5
    v_and_or_b32 v178, v25, s34, v5
    v_mfma_f32_16x16x32_bf16 v[128:131], v[192:195], v[216:219], v[128:131]
    v_and_or_b32 v179, v27, s34, v5
    s_waitcnt lgkmcnt(4)
    s_nop 0
    v_mfma_f32_16x16x32_bf16 v[108:111], v[172:175], v[220:223], v[108:111]
    ds_read_b128 v[212:215], v3 offset:1024
    v_lshrrev_b64 v[22:23], 4, v[66:67]
    v_lshrrev_b64 v[24:25], 8, v[66:67]
    v_lshrrev_b64 v[26:27], 12, v[66:67]
    v_mfma_f32_16x16x32_bf16 v[124:127], v[172:175], v[224:227], v[124:127]
    v_and_or_b32 v188, v66, s34, v5
    v_and_or_b32 v189, v22, s34, v5
    v_and_or_b32 v190, v24, s34, v5
    v_and_or_b32 v191, v26, s34, v5
    v_mfma_f32_16x16x32_bf16 v[112:115], v[176:179], v[220:223], v[112:115]
    ds_read_b128 v[216:219], v3 offset:19456
    v_and_or_b32 v192, v67, s34, v5
    v_and_or_b32 v193, v23, s34, v5
    v_and_or_b32 v194, v25, s34, v5
    v_mfma_f32_16x16x32_bf16 v[128:131], v[176:179], v[224:227], v[128:131]
    v_and_or_b32 v195, v27, s34, v5
    s_waitcnt lgkmcnt(4)
    s_nop 0
    v_mfma_f32_16x16x32_bf16 v[108:111], v[188:191], v[228:231], v[108:111]
    v_lshrrev_b64 v[22:23], 4, v[68:69]
    v_lshrrev_b64 v[24:25], 8, v[68:69]
    v_lshrrev_b64 v[26:27], 12, v[68:69]
    v_mfma_f32_16x16x32_bf16 v[124:127], v[188:191], v[232:235], v[124:127]
    v_and_or_b32 v172, v68, s34, v5
    v_and_or_b32 v173, v22, s34, v5
    v_and_or_b32 v174, v24, s34, v5
    v_mfma_f32_16x16x32_bf16 v[112:115], v[192:195], v[228:231], v[112:115]
    v_and_or_b32 v175, v26, s34, v5
    v_and_or_b32 v176, v69, s34, v5
    v_and_or_b32 v177, v23, s34, v5
    v_mfma_f32_16x16x32_bf16 v[128:131], v[192:195], v[232:235], v[128:131]
    v_and_or_b32 v178, v25, s34, v5
    v_and_or_b32 v179, v27, s34, v5
    s_waitcnt lgkmcnt(2)
    s_nop 0
    v_mfma_f32_16x16x32_bf16 v[108:111], v[172:175], v[204:207], v[108:111]
    v_lshrrev_b64 v[22:23], 4, v[70:71]
    v_lshrrev_b64 v[24:25], 8, v[70:71]
    v_lshrrev_b64 v[26:27], 12, v[70:71]
    v_mfma_f32_16x16x32_bf16 v[124:127], v[172:175], v[208:211], v[124:127]
    v_and_or_b32 v188, v70, s34, v5
    v_and_or_b32 v189, v22, s34, v5
    v_and_or_b32 v190, v24, s34, v5
    v_mfma_f32_16x16x32_bf16 v[112:115], v[176:179], v[204:207], v[112:115]
    v_and_or_b32 v191, v26, s34, v5
    v_and_or_b32 v192, v71, s34, v5
    v_and_or_b32 v193, v23, s34, v5
    v_mfma_f32_16x16x32_bf16 v[128:131], v[176:179], v[208:211], v[128:131]
    v_and_or_b32 v194, v25, s34, v5
    v_and_or_b32 v195, v27, s34, v5
    s_waitcnt lgkmcnt(0)
    s_nop 0
    v_mfma_f32_16x16x32_bf16 v[108:111], v[188:191], v[212:215], v[108:111]
    ds_read_b128 v[76:79], v14 offset:0
    ds_read_b128 v[80:83], v14 offset:16
    v_mfma_f32_16x16x32_bf16 v[124:127], v[188:191], v[216:219], v[124:127]
    ds_read_b128 v[84:87], v14 offset:2304
    v_mfma_f32_16x16x32_bf16 v[112:115], v[192:195], v[212:215], v[112:115]
    ds_read_b128 v[88:91], v14 offset:2320
    ds_read_b32 v6, v19 offset:0
    v_mfma_f32_16x16x32_bf16 v[128:131], v[192:195], v[216:219], v[128:131]
    ds_read_b32 v7, v19 offset:64
    s_setprio 3
    s_nop 7
    s_waitcnt lgkmcnt(0)
    v_fma_f32 v108, -v84, v6, v108
    v_fma_f32 v112, -v85, v6, v112
    v_fma_f32 v109, -v86, v6, v109
    v_fma_f32 v113, -v87, v6, v113
    v_fma_f32 v110, -v88, v6, v110
    v_fma_f32 v114, -v89, v6, v114
    v_fma_f32 v111, -v90, v6, v111
    v_fma_f32 v115, -v91, v6, v115
    v_mul_f32 v108, v108, v76
    v_mul_f32 v112, v112, v77
    v_mul_f32 v109, v109, v78
    v_mul_f32 v113, v113, v79
    v_mul_f32 v110, v110, v80
    v_mul_f32 v114, v114, v81
    v_mul_f32 v111, v111, v82
    v_mul_f32 v115, v115, v83
    v_cvt_pk_bf16_f32 v236, v108, v112
    v_cvt_pk_bf16_f32 v237, v109, v113
    v_cvt_pk_bf16_f32 v238, v110, v114
    v_cvt_pk_bf16_f32 v239, v111, v115
    ds_write_b128 v10, v[236:239] offset:0
    ds_read_b128 v[204:207], v12 offset:0
    v_fma_f32 v124, -v84, v7, v124
    v_fma_f32 v128, -v85, v7, v128
    v_fma_f32 v125, -v86, v7, v125
    v_fma_f32 v129, -v87, v7, v129
    v_fma_f32 v126, -v88, v7, v126
    v_fma_f32 v130, -v89, v7, v130
    v_fma_f32 v127, -v90, v7, v127
    v_fma_f32 v131, -v91, v7, v131
    v_mul_f32 v124, v124, v76
    v_mul_f32 v128, v128, v77
    v_mul_f32 v125, v125, v78
    v_mul_f32 v129, v129, v79
    v_mul_f32 v126, v126, v80
    v_mul_f32 v130, v130, v81
    v_mul_f32 v127, v127, v82
    v_mul_f32 v131, v131, v83
    v_cvt_pk_bf16_f32 v240, v124, v128
    v_cvt_pk_bf16_f32 v241, v125, v129
    v_cvt_pk_bf16_f32 v242, v126, v130
    v_cvt_pk_bf16_f32 v243, v127, v131
    ds_write_b128 v10, v[240:243] offset:1024
    ds_read_b128 v[208:211], v12 offset:1024
    s_waitcnt lgkmcnt(2)
    buffer_store_dwordx4 v[204:207], v13, s[24:27], s52 offen sc1 nt
    s_waitcnt lgkmcnt(0)
    buffer_store_dwordx4 v[208:211], v13, s[24:27], s53 offen sc1 nt
    s_branch L_fin
L_stage:
    s_setprio 3
    v_lshrrev_b32 v1, 3, v15
    s_lshl_b32 s41, s29, 4
    v_add_u32 v1, s41, v1
    v_and_b32 v18, 7, v15
    v_mul_u32_u24 v31, 1152, v1
    v_lshl_add_u32 v22, v18, 4, v31
    v_bfe_u32 v24, v1, 1, 3
    v_xor_b32 v24, v24, v18
    v_xor_b32 v25, 4, v24
    v_lshl_add_u32 v24, v24, 4, v31
    v_lshl_add_u32 v25, v25, 4, v31
    v_add_u32 v25, 9216, v25
    v_lshrrev_b32 v1, 4, v15
    v_bfe_u32 v31, v15, 3, 1
    v_lshl_add_u32 v1, v1, 3, v31
    s_lshl_b32 s41, s29, 6
    s_add_u32 s41, s41, 78336
    v_lshl_add_u32 v30, v1, 2, s41
    v_mov_b32 v1, 78592
    v_cmp_gt_u32 vcc, 32, v15
    v_add_u32 v31, 4, v17
    s_nop 0
    v_cndmask_b32 v30, v1, v30, vcc
    v_mov_b32 v1, 0x3f803f80
    v_cmp_eq_u32 vcc, v16, v17
    v_cmp_eq_u32 s[50:51], v16, v31
    s_nop 1
    v_cndmask_b32 v236, 0, v1, vcc
    v_cndmask_b32 v240, 0, v1, s[50:51]
    v_cndmask_b32 v237, 0, v1, vcc
    v_cndmask_b32 v241, 0, v1, s[50:51]
    v_cndmask_b32 v238, 0, v1, vcc
    v_cndmask_b32 v242, 0, v1, s[50:51]
    v_cndmask_b32 v239, 0, v1, vcc
    v_cndmask_b32 v243, 0, v1, s[50:51]
    s_mov_b32 s44, 0x05040100
    s_mov_b32 s45, 0x07060302
    v_mov_b32 v26, 0x3f803f80
    v_mov_b32 v28, 0
    v_mov_b32 v29, 0
    s_waitcnt lgkmcnt(0)
    s_mov_b32 s8, s64
    s_and_b32 s9, s65, 0xffff
    s_mov_b32 s10, 2359296
    s_mov_b32 s11, 0x00020000
    buffer_load_dwordx4 v[108:111], v22, s[8:11], s48 offen offset:0
    buffer_load_dwordx4 v[112:115], v22, s[8:11], s49 offen offset:0
    buffer_load_dwordx4 v[116:119], v22, s[8:11], s48 offen offset:128
    buffer_load_dwordx4 v[120:123], v22, s[8:11], s49 offen offset:128
    buffer_load_dwordx4 v[124:127], v22, s[8:11], s48 offen offset:256
    buffer_load_dwordx4 v[128:131], v22, s[8:11], s49 offen offset:256
    buffer_load_dwordx4 v[132:135], v22, s[8:11], s48 offen offset:384
    buffer_load_dwordx4 v[136:139], v22, s[8:11], s49 offen offset:384
    s_mov_b32 s12, s66
    s_and_b32 s13, s67, 0xffff
    s_mov_b32 s14, 1327104
    s_mov_b32 s15, 0x00020000
    s_mov_b32 s24, s72
    s_and_b32 s25, s73, 0xffff
    s_mov_b32 s26, 18874368
    s_mov_b32 s27, 0x00020000
    s_mov_b32 s34, 0x000f000f
    v_mov_b32 v5, 0x43004300
    s_mul_i32 s33, s31, 589824
    s_mul_i32 s42, s32, 1152
    s_add_u32 s33, s33, s42
    v_mul_u32_u24 v18, 1152, v16
    v_lshrrev_b32 v1, 1, v16
    v_xor_b32 v1, v1, v17
    v_lshl_add_u32 v2, v1, 4, v18
    v_xor_b32 v1, 4, v1
    v_lshl_add_u32 v3, v1, 4, v18
    s_lshl_b32 s42, s28, 12
    s_add_u32 s42, s42, 78848
    v_and_b32 v1, 7, v16
    v_lshlrev_b32 v18, 1, v17
    v_xor_b32 v1, v1, v18
    v_lshlrev_b32 v18, 7, v16
    v_add_u32 v18, s42, v18
    v_lshl_add_u32 v10, v1, 4, v18
    v_xor_b32 v1, 1, v1
    v_lshl_add_u32 v11, v1, 4, v18
    v_lshrrev_b32 v1, 3, v15
    v_and_b32 v18, 7, v15
    v_xor_b32 v12, v1, v18
    v_lshlrev_b32 v12, 4, v12
    v_lshl_add_u32 v12, v1, 7, v12
    v_add_u32 v12, s42, v12
    v_mul_u32_u24 v13, 9216, v1
    v_lshl_add_u32 v13, v18, 4, v13
    s_lshl_b32 s42, s28, 8
    s_add_u32 s42, s42, 73728
    v_lshl_add_u32 v14, v17, 6, s42
    v_lshlrev_b32 v19, 2, v16
    v_add_u32 v19, 78336, v19
    s_lshl_b32 s41, s28, 7
    s_add_u32 s52, s33, s41
    s_add_u32 s53, s52, 73728
    s_add_u32 s54, s52, 147456
    s_add_u32 s55, s52, 221184
    s_add_u32 s56, s52, 294912
    s_add_u32 s57, s52, 368640
    s_add_u32 s58, s52, 442368
    s_add_u32 s59, s52, 516096
    s_waitcnt vmcnt(7)
    v_perm_b32 v204, v110, v108, s44
    v_perm_b32 v205, v110, v108, s45
    v_perm_b32 v206, v111, v109, s44
    v_perm_b32 v207, v111, v109, s45
    ds_write_b128 v24, v[204:207] offset:0
    s_waitcnt vmcnt(6)
    v_perm_b32 v208, v114, v112, s44
    v_perm_b32 v209, v114, v112, s45
    v_perm_b32 v210, v115, v113, s44
    v_perm_b32 v211, v115, v113, s45
    ds_write_b128 v25, v[208:211] offset:0
    buffer_load_dwordx4 v[140:143], v22, s[8:11], s48 offen offset:512
    buffer_load_dwordx4 v[144:147], v22, s[8:11], s49 offen offset:512
    s_waitcnt vmcnt(7)
    v_perm_b32 v212, v118, v116, s44
    v_perm_b32 v213, v118, v116, s45
    v_perm_b32 v214, v119, v117, s44
    v_perm_b32 v215, v119, v117, s45
    ds_write_b128 v24, v[212:215] offset:128
    s_waitcnt vmcnt(6)
    v_perm_b32 v216, v122, v120, s44
    v_perm_b32 v217, v122, v120, s45
    v_perm_b32 v218, v123, v121, s44
    v_perm_b32 v219, v123, v121, s45
    ds_write_b128 v25, v[216:219] offset:128
    buffer_load_dwordx4 v[148:151], v22, s[8:11], s48 offen offset:640
    buffer_load_dwordx4 v[152:155], v22, s[8:11], s49 offen offset:640
    s_waitcnt lgkmcnt(0)
    s_barrier
    v_mfma_f32_16x16x32_bf16 v[244:247], v[236:239], v[108:111], 0
    v_mfma_f32_16x16x32_bf16 v[244:247], v[240:243], v[112:115], v[244:247]
    v_mfma_f32_16x16x32_bf16 v[244:247], v[236:239], v[116:119], v[244:247]
    v_mfma_f32_16x16x32_bf16 v[244:247], v[240:243], v[120:123], v[244:247]
    s_waitcnt vmcnt(7)
    v_perm_b32 v204, v126, v124, s44
    v_perm_b32 v205, v126, v124, s45
    v_perm_b32 v206, v127, v125, s44
    v_perm_b32 v207, v127, v125, s45
    ds_write_b128 v24, v[204:207] offset:256
    s_waitcnt vmcnt(6)
    v_perm_b32 v208, v130, v128, s44
    v_perm_b32 v209, v130, v128, s45
    v_perm_b32 v210, v131, v129, s44
    v_perm_b32 v211, v131, v129, s45
    ds_write_b128 v25, v[208:211] offset:256
    buffer_load_dwordx4 v[156:159], v22, s[8:11], s48 offen offset:768
    buffer_load_dwordx4 v[160:163], v22, s[8:11], s49 offen offset:768
    s_waitcnt vmcnt(7)
    v_perm_b32 v212, v134, v132, s44
    v_perm_b32 v213, v134, v132, s45
    v_perm_b32 v214, v135, v133, s44
    v_perm_b32 v215, v135, v133, s45
    ds_write_b128 v24, v[212:215] offset:384
    s_waitcnt vmcnt(6)
    v_perm_b32 v216, v138, v136, s44
    v_perm_b32 v217, v138, v136, s45
    v_perm_b32 v218, v139, v137, s44
    v_perm_b32 v219, v139, v137, s45
    ds_write_b128 v25, v[216:219] offset:384
    buffer_load_dwordx4 v[164:167], v22, s[8:11], s48 offen offset:896
    buffer_load_dwordx4 v[168:171], v22, s[8:11], s49 offen offset:896
    s_waitcnt lgkmcnt(0)
    s_barrier
    v_mfma_f32_16x16x32_bf16 v[244:247], v[236:239], v[124:127], v[244:247]
    v_mfma_f32_16x16x32_bf16 v[244:247], v[240:243], v[128:131], v[244:247]
    v_mfma_f32_16x16x32_bf16 v[244:247], v[236:239], v[132:135], v[244:247]
    v_mfma_f32_16x16x32_bf16 v[244:247], v[240:243], v[136:139], v[244:247]
    s_waitcnt vmcnt(7)
    v_perm_b32 v204, v142, v140, s44
    v_perm_b32 v205, v142, v140, s45
    v_perm_b32 v206, v143, v141, s44
    v_perm_b32 v207, v143, v141, s45
    ds_write_b128 v24, v[204:207] offset:512
    s_waitcnt vmcnt(6)
    v_perm_b32 v208, v146, v144, s44
    v_perm_b32 v209, v146, v144, s45
    v_perm_b32 v210, v147, v145, s44
    v_perm_b32 v211, v147, v145, s45
    ds_write_b128 v25, v[208:211] offset:512
    buffer_load_dwordx4 v[172:175], v22, s[8:11], s48 offen offset:1024
    buffer_load_dwordx4 v[176:179], v22, s[8:11], s49 offen offset:1024
    s_waitcnt vmcnt(7)
    v_perm_b32 v212, v150, v148, s44
    v_perm_b32 v213, v150, v148, s45
    v_perm_b32 v214, v151, v149, s44
    v_perm_b32 v215, v151, v149, s45
    ds_write_b128 v24, v[212:215] offset:640
    s_waitcnt vmcnt(6)
    v_perm_b32 v216, v154, v152, s44
    v_perm_b32 v217, v154, v152, s45
    v_perm_b32 v218, v155, v153, s44
    v_perm_b32 v219, v155, v153, s45
    ds_write_b128 v25, v[216:219] offset:640
    buffer_load_dwordx4 v[36:39], v4, s[12:15], s80 offen
    buffer_load_dwordx4 v[40:43], v4, s[12:15], s81 offen
    buffer_load_dwordx4 v[44:47], v4, s[12:15], s82 offen
    buffer_load_dwordx4 v[48:51], v4, s[12:15], s83 offen
    s_waitcnt lgkmcnt(0)
    s_barrier
    v_mfma_f32_16x16x32_bf16 v[244:247], v[236:239], v[140:143], v[244:247]
    v_mfma_f32_16x16x32_bf16 v[244:247], v[240:243], v[144:147], v[244:247]
    v_mfma_f32_16x16x32_bf16 v[244:247], v[236:239], v[148:151], v[244:247]
    v_mfma_f32_16x16x32_bf16 v[244:247], v[240:243], v[152:155], v[244:247]
    s_waitcnt vmcnt(9)
    v_perm_b32 v204, v158, v156, s44
    v_perm_b32 v205, v158, v156, s45
    v_perm_b32 v206, v159, v157, s44
    v_perm_b32 v207, v159, v157, s45
    ds_write_b128 v24, v[204:207] offset:768
    s_waitcnt vmcnt(8)
    v_perm_b32 v208, v162, v160, s44
    v_perm_b32 v209, v162, v160, s45
    v_perm_b32 v210, v163, v161, s44
    v_perm_b32 v211, v163, v161, s45
    ds_write_b128 v25, v[208:211] offset:768
    buffer_load_dwordx4 v[52:55], v4, s[12:15], s84 offen
    buffer_load_dwordx4 v[56:59], v4, s[12:15], s85 offen
    buffer_load_dwordx4 v[60:63], v4, s[12:15], s86 offen
    buffer_load_dwordx4 v[64:67], v4, s[12:15], s87 offen
    s_waitcnt vmcnt(11)
    v_perm_b32 v212, v166, v164, s44
    v_perm_b32 v213, v166, v164, s45
    v_perm_b32 v214, v167, v165, s44
    v_perm_b32 v215, v167, v165, s45
    ds_write_b128 v24, v[212:215] offset:896
    s_waitcnt vmcnt(10)
    v_perm_b32 v216, v170, v168, s44
    v_perm_b32 v217, v170, v168, s45
    v_perm_b32 v218, v171, v169, s44
    v_perm_b32 v219, v171, v169, s45
    ds_write_b128 v25, v[216:219] offset:896
    buffer_load_dwordx4 v[68:71], v4, s[12:15], s88 offen
    buffer_load_dwordx4 v[72:75], v4, s[12:15], s89 offen
    buffer_load_dwordx4 v[76:79], v4, s[12:15], s90 offen
    buffer_load_dwordx4 v[80:83], v4, s[12:15], s91 offen
    s_waitcnt vmcnt(13)
    v_perm_b32 v204, v174, v172, s44
    v_perm_b32 v205, v174, v172, s45
    v_perm_b32 v206, v175, v173, s44
    v_perm_b32 v207, v175, v173, s45
    ds_write_b128 v24, v[204:207] offset:1024
    s_waitcnt vmcnt(12)
    v_perm_b32 v208, v178, v176, s44
    v_perm_b32 v209, v178, v176, s45
    v_perm_b32 v210, v179, v177, s44
    v_perm_b32 v211, v179, v177, s45
    ds_write_b128 v25, v[208:211] offset:1024
    v_mfma_f32_16x16x32_bf16 v[244:247], v[236:239], v[156:159], v[244:247]
    v_mfma_f32_16x16x32_bf16 v[244:247], v[240:243], v[160:163], v[244:247]
    v_mfma_f32_16x16x32_bf16 v[244:247], v[236:239], v[164:167], v[244:247]
    v_mfma_f32_16x16x32_bf16 v[244:247], v[240:243], v[168:171], v[244:247]
    v_mfma_f32_16x16x32_bf16 v[244:247], v[236:239], v[172:175], v[244:247]
    v_mfma_f32_16x16x32_bf16 v[244:247], v[240:243], v[176:179], v[244:247]
    s_nop 7
    s_nop 1
    v_add_f32_dpp v244, v244, v244 quad_perm:[1,0,3,2] row_mask:0xf bank_mask:0xf
    v_add_f32_dpp v245, v245, v245 quad_perm:[1,0,3,2] row_mask:0xf bank_mask:0xf
    v_add_f32_dpp v246, v246, v246 quad_perm:[1,0,3,2] row_mask:0xf bank_mask:0xf
    v_add_f32_dpp v247, v247, v247 quad_perm:[1,0,3,2] row_mask:0xf bank_mask:0xf
    v_add_f32_dpp v244, v244, v244 quad_perm:[2,3,0,1] row_mask:0xf bank_mask:0xf
    v_add_f32_dpp v245, v245, v245 quad_perm:[2,3,0,1] row_mask:0xf bank_mask:0xf
    v_add_f32_dpp v246, v246, v246 quad_perm:[2,3,0,1] row_mask:0xf bank_mask:0xf
    v_add_f32_dpp v247, v247, v247 quad_perm:[2,3,0,1] row_mask:0xf bank_mask:0xf
    v_add_f32_dpp v244, v244, v244 row_half_mirror row_mask:0xf bank_mask:0xf
    v_add_f32_dpp v245, v245, v245 row_half_mirror row_mask:0xf bank_mask:0xf
    v_add_f32_dpp v246, v246, v246 row_half_mirror row_mask:0xf bank_mask:0xf
    v_add_f32_dpp v247, v247, v247 row_half_mirror row_mask:0xf bank_mask:0xf
    ds_write_b32 v30, v244 offset:0
    ds_write_b32 v30, v245 offset:8
    ds_write_b32 v30, v246 offset:16
    ds_write_b32 v30, v247 offset:24
    s_waitcnt lgkmcnt(0)
    s_barrier
    s_setprio 1
    ds_read_b128 v[236:239], v14 offset:2304
    ds_read_b128 v[240:243], v14 offset:2320
    ds_read_b128 v[244:247], v14 offset:2336
    ds_read_b128 v[248:251], v14 offset:2352
    ds_read_b32 v6, v19 offset:0
    ds_read_b32 v7, v19 offset:64
    ds_read_b32 v8, v19 offset:128
    ds_read_b32 v9, v19 offset:192
    ds_read_b128 v[204:207], v2 offset:0
    ds_read_b128 v[208:211], v2 offset:18432
    ds_read_b128 v[212:215], v2 offset:36864
    ds_read_b128 v[216:219], v2 offset:55296
    s_waitcnt lgkmcnt(4)
    v_mul_f32_e64 v108, -v236, v6
    v_mul_f32_e64 v112, -v237, v6
    v_mul_f32_e64 v116, -v238, v6
    v_mul_f32_e64 v120, -v239, v6
    v_mul_f32_e64 v109, -v240, v6
    v_mul_f32_e64 v113, -v241, v6
    v_mul_f32_e64 v117, -v242, v6
    v_mul_f32_e64 v121, -v243, v6
    v_mul_f32_e64 v110, -v244, v6
    v_mul_f32_e64 v114, -v245, v6
    v_mul_f32_e64 v118, -v246, v6
    v_mul_f32_e64 v122, -v247, v6
    v_mul_f32_e64 v111, -v248, v6
    v_mul_f32_e64 v115, -v249, v6
    v_mul_f32_e64 v119, -v250, v6
    v_mul_f32_e64 v123, -v251, v6
    v_mul_f32_e64 v124, -v236, v7
    v_mul_f32_e64 v128, -v237, v7
    v_mul_f32_e64 v132, -v238, v7
    v_mul_f32_e64 v136, -v239, v7
    v_mul_f32_e64 v125, -v240, v7
    v_mul_f32_e64 v129, -v241, v7
    v_mul_f32_e64 v133, -v242, v7
    v_mul_f32_e64 v137, -v243, v7
    v_mul_f32_e64 v126, -v244, v7
    v_mul_f32_e64 v130, -v245, v7
    v_mul_f32_e64 v134, -v246, v7
    v_mul_f32_e64 v138, -v247, v7
    v_mul_f32_e64 v127, -v248, v7
    v_mul_f32_e64 v131, -v249, v7
    v_mul_f32_e64 v135, -v250, v7
    v_mul_f32_e64 v139, -v251, v7
    v_mul_f32_e64 v140, -v236, v8
    v_mul_f32_e64 v144, -v237, v8
    v_mul_f32_e64 v148, -v238, v8
    v_mul_f32_e64 v152, -v239, v8
    v_mul_f32_e64 v141, -v240, v8
    v_mul_f32_e64 v145, -v241, v8
    v_mul_f32_e64 v149, -v242, v8
    v_mul_f32_e64 v153, -v243, v8
    v_mul_f32_e64 v142, -v244, v8
    v_mul_f32_e64 v146, -v245, v8
    v_mul_f32_e64 v150, -v246, v8
    v_mul_f32_e64 v154, -v247, v8
    v_mul_f32_e64 v143, -v248, v8
    v_mul_f32_e64 v147, -v249, v8
    v_mul_f32_e64 v151, -v250, v8
    v_mul_f32_e64 v155, -v251, v8
    v_mul_f32_e64 v156, -v236, v9
    v_mul_f32_e64 v160, -v237, v9
    v_mul_f32_e64 v164, -v238, v9
    v_mul_f32_e64 v168, -v239, v9
    v_mul_f32_e64 v157, -v240, v9
    v_mul_f32_e64 v161, -v241, v9
    v_mul_f32_e64 v165, -v242, v9
    v_mul_f32_e64 v169, -v243, v9
    v_mul_f32_e64 v158, -v244, v9
    v_mul_f32_e64 v162, -v245, v9
    v_mul_f32_e64 v166, -v246, v9
    v_mul_f32_e64 v170, -v247, v9
    v_mul_f32_e64 v159, -v248, v9
    v_mul_f32_e64 v163, -v249, v9
    v_mul_f32_e64 v167, -v250, v9
    v_mul_f32_e64 v171, -v251, v9
    s_waitcnt vmcnt(11)
    v_lshrrev_b64 v[22:23], 4, v[36:37]
    v_lshrrev_b64 v[24:25], 8, v[36:37]
    v_lshrrev_b64 v[26:27], 12, v[36:37]
    v_and_or_b32 v172, v36, s34, v5
    v_and_or_b32 v173, v22, s34, v5
    v_and_or_b32 v174, v24, s34, v5
    v_and_or_b32 v175, v26, s34, v5
    v_and_or_b32 v176, v37, s34, v5
    v_and_or_b32 v177, v23, s34, v5
    v_and_or_b32 v178, v25, s34, v5
    v_and_or_b32 v179, v27, s34, v5
    v_lshrrev_b64 v[28:29], 4, v[38:39]
    v_lshrrev_b64 v[30:31], 8, v[38:39]
    v_lshrrev_b64 v[32:33], 12, v[38:39]
    v_and_or_b32 v180, v38, s34, v5
    v_and_or_b32 v181, v28, s34, v5
    v_and_or_b32 v182, v30, s34, v5
    v_and_or_b32 v183, v32, s34, v5
    v_and_or_b32 v184, v39, s34, v5
    v_and_or_b32 v185, v29, s34, v5
    v_and_or_b32 v186, v31, s34, v5
    v_and_or_b32 v187, v33, s34, v5
.p2align 3
    s_waitcnt vmcnt(10)
    s_waitcnt lgkmcnt(0)
    v_mfma_f32_16x16x32_bf16 v[108:111], v[172:175], v[204:207], v[108:111]
    ds_read_b128 v[220:223], v3 offset:0
    v_lshrrev_b64 v[22:23], 4, v[40:41]
    v_mfma_f32_16x16x32_bf16 v[124:127], v[172:175], v[208:211], v[124:127]
    v_lshrrev_b64 v[24:25], 8, v[40:41]
    v_lshrrev_b64 v[26:27], 12, v[40:41]
    v_mfma_f32_16x16x32_bf16 v[140:143], v[172:175], v[212:215], v[140:143]
    ds_read_b128 v[224:227], v3 offset:18432
    v_and_or_b32 v188, v40, s34, v5
    v_mfma_f32_16x16x32_bf16 v[156:159], v[172:175], v[216:219], v[156:159]
    v_and_or_b32 v189, v22, s34, v5
    v_and_or_b32 v190, v24, s34, v5
    v_mfma_f32_16x16x32_bf16 v[112:115], v[176:179], v[204:207], v[112:115]
    ds_read_b128 v[228:231], v3 offset:36864
    v_and_or_b32 v191, v26, s34, v5
    v_mfma_f32_16x16x32_bf16 v[128:131], v[176:179], v[208:211], v[128:131]
    v_and_or_b32 v192, v41, s34, v5
    v_and_or_b32 v193, v23, s34, v5
    v_mfma_f32_16x16x32_bf16 v[144:147], v[176:179], v[212:215], v[144:147]
    ds_read_b128 v[232:235], v3 offset:55296
    v_and_or_b32 v194, v25, s34, v5
    v_mfma_f32_16x16x32_bf16 v[160:163], v[176:179], v[216:219], v[160:163]
    v_and_or_b32 v195, v27, s34, v5
    v_lshrrev_b64 v[28:29], 4, v[42:43]
    v_mfma_f32_16x16x32_bf16 v[116:119], v[180:183], v[204:207], v[116:119]
    buffer_load_dwordx4 v[84:87], v4, s[12:15], s92 offen
    v_mfma_f32_16x16x32_bf16 v[132:135], v[180:183], v[208:211], v[132:135]
    v_lshrrev_b64 v[30:31], 8, v[42:43]
    v_lshrrev_b64 v[32:33], 12, v[42:43]
    v_mfma_f32_16x16x32_bf16 v[148:151], v[180:183], v[212:215], v[148:151]
    v_and_or_b32 v196, v42, s34, v5
    v_and_or_b32 v197, v28, s34, v5
    v_mfma_f32_16x16x32_bf16 v[164:167], v[180:183], v[216:219], v[164:167]
    v_and_or_b32 v198, v30, s34, v5
    v_and_or_b32 v199, v32, s34, v5
    v_mfma_f32_16x16x32_bf16 v[120:123], v[184:187], v[204:207], v[120:123]
    v_and_or_b32 v200, v43, s34, v5
    v_and_or_b32 v201, v29, s34, v5
    v_mfma_f32_16x16x32_bf16 v[136:139], v[184:187], v[208:211], v[136:139]
    v_and_or_b32 v202, v31, s34, v5
    v_and_or_b32 v203, v33, s34, v5
    v_mfma_f32_16x16x32_bf16 v[152:155], v[184:187], v[212:215], v[152:155]
    v_mfma_f32_16x16x32_bf16 v[168:171], v[184:187], v[216:219], v[168:171]
    s_waitcnt vmcnt(10)
    s_waitcnt lgkmcnt(0)
    v_mfma_f32_16x16x32_bf16 v[108:111], v[188:191], v[220:223], v[108:111]
    ds_read_b128 v[204:207], v2 offset:128
    v_lshrrev_b64 v[22:23], 4, v[44:45]
    v_mfma_f32_16x16x32_bf16 v[124:127], v[188:191], v[224:227], v[124:127]
    v_lshrrev_b64 v[24:25], 8, v[44:45]
    v_lshrrev_b64 v[26:27], 12, v[44:45]
    v_mfma_f32_16x16x32_bf16 v[140:143], v[188:191], v[228:231], v[140:143]
    ds_read_b128 v[208:211], v2 offset:18560
    v_and_or_b32 v172, v44, s34, v5
    v_mfma_f32_16x16x32_bf16 v[156:159], v[188:191], v[232:235], v[156:159]
    v_and_or_b32 v173, v22, s34, v5
    v_and_or_b32 v174, v24, s34, v5
    v_mfma_f32_16x16x32_bf16 v[112:115], v[192:195], v[220:223], v[112:115]
    ds_read_b128 v[212:215], v2 offset:36992
    v_and_or_b32 v175, v26, s34, v5
    v_mfma_f32_16x16x32_bf16 v[128:131], v[192:195], v[224:227], v[128:131]
    v_and_or_b32 v176, v45, s34, v5
    v_and_or_b32 v177, v23, s34, v5
    v_mfma_f32_16x16x32_bf16 v[144:147], v[192:195], v[228:231], v[144:147]
    ds_read_b128 v[216:219], v2 offset:55424
    v_and_or_b32 v178, v25, s34, v5
    v_mfma_f32_16x16x32_bf16 v[160:163], v[192:195], v[232:235], v[160:163]
    v_and_or_b32 v179, v27, s34, v5
    v_lshrrev_b64 v[28:29], 4, v[46:47]
    v_mfma_f32_16x16x32_bf16 v[116:119], v[196:199], v[220:223], v[116:119]
    buffer_load_dwordx4 v[88:91], v4, s[12:15], s93 offen
    v_mfma_f32_16x16x32_bf16 v[132:135], v[196:199], v[224:227], v[132:135]
    v_lshrrev_b64 v[30:31], 8, v[46:47]
    v_lshrrev_b64 v[32:33], 12, v[46:47]
    v_mfma_f32_16x16x32_bf16 v[148:151], v[196:199], v[228:231], v[148:151]
    v_and_or_b32 v180, v46, s34, v5
    v_and_or_b32 v181, v28, s34, v5
    v_mfma_f32_16x16x32_bf16 v[164:167], v[196:199], v[232:235], v[164:167]
    v_and_or_b32 v182, v30, s34, v5
    v_and_or_b32 v183, v32, s34, v5
    v_mfma_f32_16x16x32_bf16 v[120:123], v[200:203], v[220:223], v[120:123]
    v_and_or_b32 v184, v47, s34, v5
    v_and_or_b32 v185, v29, s34, v5
    v_mfma_f32_16x16x32_bf16 v[136:139], v[200:203], v[224:227], v[136:139]
    v_and_or_b32 v186, v31, s34, v5
    v_and_or_b32 v187, v33, s34, v5
    v_mfma_f32_16x16x32_bf16 v[152:155], v[200:203], v[228:231], v[152:155]
    v_mfma_f32_16x16x32_bf16 v[168:171], v[200:203], v[232:235], v[168:171]
    s_waitcnt vmcnt(10)
    s_waitcnt lgkmcnt(0)
    v_mfma_f32_16x16x32_bf16 v[108:111], v[172:175], v[204:207], v[108:111]
    ds_read_b128 v[220:223], v3 offset:128
    v_lshrrev_b64 v[22:23], 4, v[48:49]
    v_mfma_f32_16x16x32_bf16 v[124:127], v[172:175], v[208:211], v[124:127]
    v_lshrrev_b64 v[24:25], 8, v[48:49]
    v_lshrrev_b64 v[26:27], 12, v[48:49]
    v_mfma_f32_16x16x32_bf16 v[140:143], v[172:175], v[212:215], v[140:143]
    ds_read_b128 v[224:227], v3 offset:18560
    v_and_or_b32 v188, v48, s34, v5
    v_mfma_f32_16x16x32_bf16 v[156:159], v[172:175], v[216:219], v[156:159]
    v_and_or_b32 v189, v22, s34, v5
    v_and_or_b32 v190, v24, s34, v5
    v_mfma_f32_16x16x32_bf16 v[112:115], v[176:179], v[204:207], v[112:115]
    ds_read_b128 v[228:231], v3 offset:36992
    v_and_or_b32 v191, v26, s34, v5
    v_mfma_f32_16x16x32_bf16 v[128:131], v[176:179], v[208:211], v[128:131]
    v_and_or_b32 v192, v49, s34, v5
    v_and_or_b32 v193, v23, s34, v5
    v_mfma_f32_16x16x32_bf16 v[144:147], v[176:179], v[212:215], v[144:147]
    ds_read_b128 v[232:235], v3 offset:55424
    v_and_or_b32 v194, v25, s34, v5
    v_mfma_f32_16x16x32_bf16 v[160:163], v[176:179], v[216:219], v[160:163]
    v_and_or_b32 v195, v27, s34, v5
    v_lshrrev_b64 v[28:29], 4, v[50:51]
    v_mfma_f32_16x16x32_bf16 v[116:119], v[180:183], v[204:207], v[116:119]
    buffer_load_dwordx4 v[92:95], v4, s[12:15], s94 offen
    v_mfma_f32_16x16x32_bf16 v[132:135], v[180:183], v[208:211], v[132:135]
    v_lshrrev_b64 v[30:31], 8, v[50:51]
    v_lshrrev_b64 v[32:33], 12, v[50:51]
    v_mfma_f32_16x16x32_bf16 v[148:151], v[180:183], v[212:215], v[148:151]
    v_and_or_b32 v196, v50, s34, v5
    v_and_or_b32 v197, v28, s34, v5
    v_mfma_f32_16x16x32_bf16 v[164:167], v[180:183], v[216:219], v[164:167]
    v_and_or_b32 v198, v30, s34, v5
    v_and_or_b32 v199, v32, s34, v5
    v_mfma_f32_16x16x32_bf16 v[120:123], v[184:187], v[204:207], v[120:123]
    v_and_or_b32 v200, v51, s34, v5
    v_and_or_b32 v201, v29, s34, v5
    v_mfma_f32_16x16x32_bf16 v[136:139], v[184:187], v[208:211], v[136:139]
    v_and_or_b32 v202, v31, s34, v5
    v_and_or_b32 v203, v33, s34, v5
    v_mfma_f32_16x16x32_bf16 v[152:155], v[184:187], v[212:215], v[152:155]
    v_mfma_f32_16x16x32_bf16 v[168:171], v[184:187], v[216:219], v[168:171]
    s_waitcnt vmcnt(10)
    s_waitcnt lgkmcnt(0)
    v_mfma_f32_16x16x32_bf16 v[108:111], v[188:191], v[220:223], v[108:111]
    ds_read_b128 v[204:207], v2 offset:256
    v_lshrrev_b64 v[22:23], 4, v[52:53]
    v_mfma_f32_16x16x32_bf16 v[124:127], v[188:191], v[224:227], v[124:127]
    v_lshrrev_b64 v[24:25], 8, v[52:53]
    v_lshrrev_b64 v[26:27], 12, v[52:53]
    v_mfma_f32_16x16x32_bf16 v[140:143], v[188:191], v[228:231], v[140:143]
    ds_read_b128 v[208:211], v2 offset:18688
    v_and_or_b32 v172, v52, s34, v5
    v_mfma_f32_16x16x32_bf16 v[156:159], v[188:191], v[232:235], v[156:159]
    v_and_or_b32 v173, v22, s34, v5
    v_and_or_b32 v174, v24, s34, v5
    v_mfma_f32_16x16x32_bf16 v[112:115], v[192:195], v[220:223], v[112:115]
    ds_read_b128 v[212:215], v2 offset:37120
    v_and_or_b32 v175, v26, s34, v5
    v_mfma_f32_16x16x32_bf16 v[128:131], v[192:195], v[224:227], v[128:131]
    v_and_or_b32 v176, v53, s34, v5
    v_and_or_b32 v177, v23, s34, v5
    v_mfma_f32_16x16x32_bf16 v[144:147], v[192:195], v[228:231], v[144:147]
    ds_read_b128 v[216:219], v2 offset:55552
    v_and_or_b32 v178, v25, s34, v5
    v_mfma_f32_16x16x32_bf16 v[160:163], v[192:195], v[232:235], v[160:163]
    v_and_or_b32 v179, v27, s34, v5
    v_lshrrev_b64 v[28:29], 4, v[54:55]
    v_mfma_f32_16x16x32_bf16 v[116:119], v[196:199], v[220:223], v[116:119]
    buffer_load_dwordx4 v[96:99], v4, s[12:15], s95 offen
    v_mfma_f32_16x16x32_bf16 v[132:135], v[196:199], v[224:227], v[132:135]
    v_lshrrev_b64 v[30:31], 8, v[54:55]
    v_lshrrev_b64 v[32:33], 12, v[54:55]
    v_mfma_f32_16x16x32_bf16 v[148:151], v[196:199], v[228:231], v[148:151]
    v_and_or_b32 v180, v54, s34, v5
    v_and_or_b32 v181, v28, s34, v5
    v_mfma_f32_16x16x32_bf16 v[164:167], v[196:199], v[232:235], v[164:167]
    v_and_or_b32 v182, v30, s34, v5
    v_and_or_b32 v183, v32, s34, v5
    v_mfma_f32_16x16x32_bf16 v[120:123], v[200:203], v[220:223], v[120:123]
    v_and_or_b32 v184, v55, s34, v5
    v_and_or_b32 v185, v29, s34, v5
    v_mfma_f32_16x16x32_bf16 v[136:139], v[200:203], v[224:227], v[136:139]
    v_and_or_b32 v186, v31, s34, v5
    v_and_or_b32 v187, v33, s34, v5
    v_mfma_f32_16x16x32_bf16 v[152:155], v[200:203], v[228:231], v[152:155]
    v_mfma_f32_16x16x32_bf16 v[168:171], v[200:203], v[232:235], v[168:171]
    s_waitcnt vmcnt(10)
    s_waitcnt lgkmcnt(0)
    v_mfma_f32_16x16x32_bf16 v[108:111], v[172:175], v[204:207], v[108:111]
    ds_read_b128 v[220:223], v3 offset:256
    v_lshrrev_b64 v[22:23], 4, v[56:57]
    v_mfma_f32_16x16x32_bf16 v[124:127], v[172:175], v[208:211], v[124:127]
    v_lshrrev_b64 v[24:25], 8, v[56:57]
    v_lshrrev_b64 v[26:27], 12, v[56:57]
    v_mfma_f32_16x16x32_bf16 v[140:143], v[172:175], v[212:215], v[140:143]
    ds_read_b128 v[224:227], v3 offset:18688
    v_and_or_b32 v188, v56, s34, v5
    v_mfma_f32_16x16x32_bf16 v[156:159], v[172:175], v[216:219], v[156:159]
    v_and_or_b32 v189, v22, s34, v5
    v_and_or_b32 v190, v24, s34, v5
    v_mfma_f32_16x16x32_bf16 v[112:115], v[176:179], v[204:207], v[112:115]
    ds_read_b128 v[228:231], v3 offset:37120
    v_and_or_b32 v191, v26, s34, v5
    v_mfma_f32_16x16x32_bf16 v[128:131], v[176:179], v[208:211], v[128:131]
    v_and_or_b32 v192, v57, s34, v5
    v_and_or_b32 v193, v23, s34, v5
    v_mfma_f32_16x16x32_bf16 v[144:147], v[176:179], v[212:215], v[144:147]
    ds_read_b128 v[232:235], v3 offset:55552
    v_and_or_b32 v194, v25, s34, v5
    v_mfma_f32_16x16x32_bf16 v[160:163], v[176:179], v[216:219], v[160:163]
    v_and_or_b32 v195, v27, s34, v5
    v_lshrrev_b64 v[28:29], 4, v[58:59]
    v_mfma_f32_16x16x32_bf16 v[116:119], v[180:183], v[204:207], v[116:119]
    buffer_load_dwordx4 v[100:103], v4, s[12:15], s96 offen
    v_mfma_f32_16x16x32_bf16 v[132:135], v[180:183], v[208:211], v[132:135]
    v_lshrrev_b64 v[30:31], 8, v[58:59]
    v_lshrrev_b64 v[32:33], 12, v[58:59]
    v_mfma_f32_16x16x32_bf16 v[148:151], v[180:183], v[212:215], v[148:151]
    v_and_or_b32 v196, v58, s34, v5
    v_and_or_b32 v197, v28, s34, v5
    v_mfma_f32_16x16x32_bf16 v[164:167], v[180:183], v[216:219], v[164:167]
    v_and_or_b32 v198, v30, s34, v5
    v_and_or_b32 v199, v32, s34, v5
    v_mfma_f32_16x16x32_bf16 v[120:123], v[184:187], v[204:207], v[120:123]
    v_and_or_b32 v200, v59, s34, v5
    v_and_or_b32 v201, v29, s34, v5
    v_mfma_f32_16x16x32_bf16 v[136:139], v[184:187], v[208:211], v[136:139]
    v_and_or_b32 v202, v31, s34, v5
    v_and_or_b32 v203, v33, s34, v5
    v_mfma_f32_16x16x32_bf16 v[152:155], v[184:187], v[212:215], v[152:155]
    v_mfma_f32_16x16x32_bf16 v[168:171], v[184:187], v[216:219], v[168:171]
    s_waitcnt vmcnt(10)
    s_waitcnt lgkmcnt(0)
    v_mfma_f32_16x16x32_bf16 v[108:111], v[188:191], v[220:223], v[108:111]
    ds_read_b128 v[204:207], v2 offset:384
    v_lshrrev_b64 v[22:23], 4, v[60:61]
    v_mfma_f32_16x16x32_bf16 v[124:127], v[188:191], v[224:227], v[124:127]
    v_lshrrev_b64 v[24:25], 8, v[60:61]
    v_lshrrev_b64 v[26:27], 12, v[60:61]
    v_mfma_f32_16x16x32_bf16 v[140:143], v[188:191], v[228:231], v[140:143]
    ds_read_b128 v[208:211], v2 offset:18816
    v_and_or_b32 v172, v60, s34, v5
    v_mfma_f32_16x16x32_bf16 v[156:159], v[188:191], v[232:235], v[156:159]
    v_and_or_b32 v173, v22, s34, v5
    v_and_or_b32 v174, v24, s34, v5
    v_mfma_f32_16x16x32_bf16 v[112:115], v[192:195], v[220:223], v[112:115]
    ds_read_b128 v[212:215], v2 offset:37248
    v_and_or_b32 v175, v26, s34, v5
    v_mfma_f32_16x16x32_bf16 v[128:131], v[192:195], v[224:227], v[128:131]
    v_and_or_b32 v176, v61, s34, v5
    v_and_or_b32 v177, v23, s34, v5
    v_mfma_f32_16x16x32_bf16 v[144:147], v[192:195], v[228:231], v[144:147]
    ds_read_b128 v[216:219], v2 offset:55680
    v_and_or_b32 v178, v25, s34, v5
    v_mfma_f32_16x16x32_bf16 v[160:163], v[192:195], v[232:235], v[160:163]
    v_and_or_b32 v179, v27, s34, v5
    v_lshrrev_b64 v[28:29], 4, v[62:63]
    v_mfma_f32_16x16x32_bf16 v[116:119], v[196:199], v[220:223], v[116:119]
    buffer_load_dwordx4 v[104:107], v4, s[12:15], s97 offen
    v_mfma_f32_16x16x32_bf16 v[132:135], v[196:199], v[224:227], v[132:135]
    v_lshrrev_b64 v[30:31], 8, v[62:63]
    v_lshrrev_b64 v[32:33], 12, v[62:63]
    v_mfma_f32_16x16x32_bf16 v[148:151], v[196:199], v[228:231], v[148:151]
    v_and_or_b32 v180, v62, s34, v5
    v_and_or_b32 v181, v28, s34, v5
    v_mfma_f32_16x16x32_bf16 v[164:167], v[196:199], v[232:235], v[164:167]
    v_and_or_b32 v182, v30, s34, v5
    v_and_or_b32 v183, v32, s34, v5
    v_mfma_f32_16x16x32_bf16 v[120:123], v[200:203], v[220:223], v[120:123]
    v_and_or_b32 v184, v63, s34, v5
    v_and_or_b32 v185, v29, s34, v5
    v_mfma_f32_16x16x32_bf16 v[136:139], v[200:203], v[224:227], v[136:139]
    v_and_or_b32 v186, v31, s34, v5
    v_and_or_b32 v187, v33, s34, v5
    v_mfma_f32_16x16x32_bf16 v[152:155], v[200:203], v[228:231], v[152:155]
    v_mfma_f32_16x16x32_bf16 v[168:171], v[200:203], v[232:235], v[168:171]
    s_waitcnt vmcnt(10)
    s_waitcnt lgkmcnt(0)
    v_mfma_f32_16x16x32_bf16 v[108:111], v[172:175], v[204:207], v[108:111]
    ds_read_b128 v[220:223], v3 offset:384
    v_lshrrev_b64 v[22:23], 4, v[64:65]
    v_mfma_f32_16x16x32_bf16 v[124:127], v[172:175], v[208:211], v[124:127]
    v_lshrrev_b64 v[24:25], 8, v[64:65]
    v_lshrrev_b64 v[26:27], 12, v[64:65]
    v_mfma_f32_16x16x32_bf16 v[140:143], v[172:175], v[212:215], v[140:143]
    ds_read_b128 v[224:227], v3 offset:18816
    v_and_or_b32 v188, v64, s34, v5
    v_mfma_f32_16x16x32_bf16 v[156:159], v[172:175], v[216:219], v[156:159]
    v_and_or_b32 v189, v22, s34, v5
    v_and_or_b32 v190, v24, s34, v5
    v_mfma_f32_16x16x32_bf16 v[112:115], v[176:179], v[204:207], v[112:115]
    ds_read_b128 v[228:231], v3 offset:37248
    v_and_or_b32 v191, v26, s34, v5
    v_mfma_f32_16x16x32_bf16 v[128:131], v[176:179], v[208:211], v[128:131]
    v_and_or_b32 v192, v65, s34, v5
    v_and_or_b32 v193, v23, s34, v5
    v_mfma_f32_16x16x32_bf16 v[144:147], v[176:179], v[212:215], v[144:147]
    ds_read_b128 v[232:235], v3 offset:55680
    v_and_or_b32 v194, v25, s34, v5
    v_mfma_f32_16x16x32_bf16 v[160:163], v[176:179], v[216:219], v[160:163]
    v_and_or_b32 v195, v27, s34, v5
    v_lshrrev_b64 v[28:29], 4, v[66:67]
    v_mfma_f32_16x16x32_bf16 v[116:119], v[180:183], v[204:207], v[116:119]
    v_lshrrev_b64 v[30:31], 8, v[66:67]
    v_lshrrev_b64 v[32:33], 12, v[66:67]
    v_mfma_f32_16x16x32_bf16 v[132:135], v[180:183], v[208:211], v[132:135]
    v_and_or_b32 v196, v66, s34, v5
    v_and_or_b32 v197, v28, s34, v5
    v_mfma_f32_16x16x32_bf16 v[148:151], v[180:183], v[212:215], v[148:151]
    v_and_or_b32 v198, v30, s34, v5
    v_and_or_b32 v199, v32, s34, v5
    v_mfma_f32_16x16x32_bf16 v[164:167], v[180:183], v[216:219], v[164:167]
    v_and_or_b32 v200, v67, s34, v5
    v_and_or_b32 v201, v29, s34, v5
    v_mfma_f32_16x16x32_bf16 v[120:123], v[184:187], v[204:207], v[120:123]
    v_and_or_b32 v202, v31, s34, v5
    v_and_or_b32 v203, v33, s34, v5
    v_mfma_f32_16x16x32_bf16 v[136:139], v[184:187], v[208:211], v[136:139]
    v_mfma_f32_16x16x32_bf16 v[152:155], v[184:187], v[212:215], v[152:155]
    v_mfma_f32_16x16x32_bf16 v[168:171], v[184:187], v[216:219], v[168:171]
    s_waitcnt vmcnt(9)
    s_waitcnt lgkmcnt(0)
    v_mfma_f32_16x16x32_bf16 v[108:111], v[188:191], v[220:223], v[108:111]
    ds_read_b128 v[204:207], v2 offset:512
    v_lshrrev_b64 v[22:23], 4, v[68:69]
    v_mfma_f32_16x16x32_bf16 v[124:127], v[188:191], v[224:227], v[124:127]
    v_lshrrev_b64 v[24:25], 8, v[68:69]
    v_lshrrev_b64 v[26:27], 12, v[68:69]
    v_mfma_f32_16x16x32_bf16 v[140:143], v[188:191], v[228:231], v[140:143]
    ds_read_b128 v[208:211], v2 offset:18944
    v_and_or_b32 v172, v68, s34, v5
    v_mfma_f32_16x16x32_bf16 v[156:159], v[188:191], v[232:235], v[156:159]
    v_and_or_b32 v173, v22, s34, v5
    v_and_or_b32 v174, v24, s34, v5
    v_mfma_f32_16x16x32_bf16 v[112:115], v[192:195], v[220:223], v[112:115]
    ds_read_b128 v[212:215], v2 offset:37376
    v_and_or_b32 v175, v26, s34, v5
    v_mfma_f32_16x16x32_bf16 v[128:131], v[192:195], v[224:227], v[128:131]
    v_and_or_b32 v176, v69, s34, v5
    v_and_or_b32 v177, v23, s34, v5
    v_mfma_f32_16x16x32_bf16 v[144:147], v[192:195], v[228:231], v[144:147]
    ds_read_b128 v[216:219], v2 offset:55808
    v_and_or_b32 v178, v25, s34, v5
    v_mfma_f32_16x16x32_bf16 v[160:163], v[192:195], v[232:235], v[160:163]
    v_and_or_b32 v179, v27, s34, v5
    v_lshrrev_b64 v[28:29], 4, v[70:71]
    v_mfma_f32_16x16x32_bf16 v[116:119], v[196:199], v[220:223], v[116:119]
    v_lshrrev_b64 v[30:31], 8, v[70:71]
    v_lshrrev_b64 v[32:33], 12, v[70:71]
    v_mfma_f32_16x16x32_bf16 v[132:135], v[196:199], v[224:227], v[132:135]
    v_and_or_b32 v180, v70, s34, v5
    v_and_or_b32 v181, v28, s34, v5
    v_mfma_f32_16x16x32_bf16 v[148:151], v[196:199], v[228:231], v[148:151]
    v_and_or_b32 v182, v30, s34, v5
    v_and_or_b32 v183, v32, s34, v5
    v_mfma_f32_16x16x32_bf16 v[164:167], v[196:199], v[232:235], v[164:167]
    v_and_or_b32 v184, v71, s34, v5
    v_and_or_b32 v185, v29, s34, v5
    v_mfma_f32_16x16x32_bf16 v[120:123], v[200:203], v[220:223], v[120:123]
    v_and_or_b32 v186, v31, s34, v5
    v_and_or_b32 v187, v33, s34, v5
    v_mfma_f32_16x16x32_bf16 v[136:139], v[200:203], v[224:227], v[136:139]
    v_mfma_f32_16x16x32_bf16 v[152:155], v[200:203], v[228:231], v[152:155]
    v_mfma_f32_16x16x32_bf16 v[168:171], v[200:203], v[232:235], v[168:171]
    s_waitcnt vmcnt(8)
    s_waitcnt lgkmcnt(0)
    v_mfma_f32_16x16x32_bf16 v[108:111], v[172:175], v[204:207], v[108:111]
    ds_read_b128 v[220:223], v3 offset:512
    v_lshrrev_b64 v[22:23], 4, v[72:73]
    v_mfma_f32_16x16x32_bf16 v[124:127], v[172:175], v[208:211], v[124:127]
    v_lshrrev_b64 v[24:25], 8, v[72:73]
    v_lshrrev_b64 v[26:27], 12, v[72:73]
    v_mfma_f32_16x16x32_bf16 v[140:143], v[172:175], v[212:215], v[140:143]
    ds_read_b128 v[224:227], v3 offset:18944
    v_and_or_b32 v188, v72, s34, v5
    v_mfma_f32_16x16x32_bf16 v[156:159], v[172:175], v[216:219], v[156:159]
    v_and_or_b32 v189, v22, s34, v5
    v_and_or_b32 v190, v24, s34, v5
    v_mfma_f32_16x16x32_bf16 v[112:115], v[176:179], v[204:207], v[112:115]
    ds_read_b128 v[228:231], v3 offset:37376
    v_and_or_b32 v191, v26, s34, v5
    v_mfma_f32_16x16x32_bf16 v[128:131], v[176:179], v[208:211], v[128:131]
    v_and_or_b32 v192, v73, s34, v5
    v_and_or_b32 v193, v23, s34, v5
    v_mfma_f32_16x16x32_bf16 v[144:147], v[176:179], v[212:215], v[144:147]
    ds_read_b128 v[232:235], v3 offset:55808
    v_and_or_b32 v194, v25, s34, v5
    v_mfma_f32_16x16x32_bf16 v[160:163], v[176:179], v[216:219], v[160:163]
    v_and_or_b32 v195, v27, s34, v5
    v_lshrrev_b64 v[28:29], 4, v[74:75]
    v_mfma_f32_16x16x32_bf16 v[116:119], v[180:183], v[204:207], v[116:119]
    v_lshrrev_b64 v[30:31], 8, v[74:75]
    v_lshrrev_b64 v[32:33], 12, v[74:75]
    v_mfma_f32_16x16x32_bf16 v[132:135], v[180:183], v[208:211], v[132:135]
    v_and_or_b32 v196, v74, s34, v5
    v_and_or_b32 v197, v28, s34, v5
    v_mfma_f32_16x16x32_bf16 v[148:151], v[180:183], v[212:215], v[148:151]
    v_and_or_b32 v198, v30, s34, v5
    v_and_or_b32 v199, v32, s34, v5
    v_mfma_f32_16x16x32_bf16 v[164:167], v[180:183], v[216:219], v[164:167]
    v_and_or_b32 v200, v75, s34, v5
    v_and_or_b32 v201, v29, s34, v5
    v_mfma_f32_16x16x32_bf16 v[120:123], v[184:187], v[204:207], v[120:123]
    v_and_or_b32 v202, v31, s34, v5
    v_and_or_b32 v203, v33, s34, v5
    v_mfma_f32_16x16x32_bf16 v[136:139], v[184:187], v[208:211], v[136:139]
    v_mfma_f32_16x16x32_bf16 v[152:155], v[184:187], v[212:215], v[152:155]
    v_mfma_f32_16x16x32_bf16 v[168:171], v[184:187], v[216:219], v[168:171]
    s_waitcnt vmcnt(7)
    s_waitcnt lgkmcnt(0)
    v_mfma_f32_16x16x32_bf16 v[108:111], v[188:191], v[220:223], v[108:111]
    ds_read_b128 v[204:207], v2 offset:640
    v_lshrrev_b64 v[22:23], 4, v[76:77]
    v_mfma_f32_16x16x32_bf16 v[124:127], v[188:191], v[224:227], v[124:127]
    v_lshrrev_b64 v[24:25], 8, v[76:77]
    v_lshrrev_b64 v[26:27], 12, v[76:77]
    v_mfma_f32_16x16x32_bf16 v[140:143], v[188:191], v[228:231], v[140:143]
    ds_read_b128 v[208:211], v2 offset:19072
    v_and_or_b32 v172, v76, s34, v5
    v_mfma_f32_16x16x32_bf16 v[156:159], v[188:191], v[232:235], v[156:159]
    v_and_or_b32 v173, v22, s34, v5
    v_and_or_b32 v174, v24, s34, v5
    v_mfma_f32_16x16x32_bf16 v[112:115], v[192:195], v[220:223], v[112:115]
    ds_read_b128 v[212:215], v2 offset:37504
    v_and_or_b32 v175, v26, s34, v5
    v_mfma_f32_16x16x32_bf16 v[128:131], v[192:195], v[224:227], v[128:131]
    v_and_or_b32 v176, v77, s34, v5
    v_and_or_b32 v177, v23, s34, v5
    v_mfma_f32_16x16x32_bf16 v[144:147], v[192:195], v[228:231], v[144:147]
    ds_read_b128 v[216:219], v2 offset:55936
    v_and_or_b32 v178, v25, s34, v5
    v_mfma_f32_16x16x32_bf16 v[160:163], v[192:195], v[232:235], v[160:163]
    v_and_or_b32 v179, v27, s34, v5
    v_lshrrev_b64 v[28:29], 4, v[78:79]
    v_mfma_f32_16x16x32_bf16 v[116:119], v[196:199], v[220:223], v[116:119]
    v_lshrrev_b64 v[30:31], 8, v[78:79]
    v_lshrrev_b64 v[32:33], 12, v[78:79]
    v_mfma_f32_16x16x32_bf16 v[132:135], v[196:199], v[224:227], v[132:135]
    v_and_or_b32 v180, v78, s34, v5
    v_and_or_b32 v181, v28, s34, v5
    v_mfma_f32_16x16x32_bf16 v[148:151], v[196:199], v[228:231], v[148:151]
    v_and_or_b32 v182, v30, s34, v5
    v_and_or_b32 v183, v32, s34, v5
    v_mfma_f32_16x16x32_bf16 v[164:167], v[196:199], v[232:235], v[164:167]
    v_and_or_b32 v184, v79, s34, v5
    v_and_or_b32 v185, v29, s34, v5
    v_mfma_f32_16x16x32_bf16 v[120:123], v[200:203], v[220:223], v[120:123]
    v_and_or_b32 v186, v31, s34, v5
    v_and_or_b32 v187, v33, s34, v5
    v_mfma_f32_16x16x32_bf16 v[136:139], v[200:203], v[224:227], v[136:139]
    v_mfma_f32_16x16x32_bf16 v[152:155], v[200:203], v[228:231], v[152:155]
    v_mfma_f32_16x16x32_bf16 v[168:171], v[200:203], v[232:235], v[168:171]
    s_waitcnt vmcnt(6)
    s_waitcnt lgkmcnt(0)
    v_mfma_f32_16x16x32_bf16 v[108:111], v[172:175], v[204:207], v[108:111]
    ds_read_b128 v[220:223], v3 offset:640
    v_lshrrev_b64 v[22:23], 4, v[80:81]
    v_mfma_f32_16x16x32_bf16 v[124:127], v[172:175], v[208:211], v[124:127]
    v_lshrrev_b64 v[24:25], 8, v[80:81]
    v_lshrrev_b64 v[26:27], 12, v[80:81]
    v_mfma_f32_16x16x32_bf16 v[140:143], v[172:175], v[212:215], v[140:143]
    ds_read_b128 v[224:227], v3 offset:19072
    v_and_or_b32 v188, v80, s34, v5
    v_mfma_f32_16x16x32_bf16 v[156:159], v[172:175], v[216:219], v[156:159]
    v_and_or_b32 v189, v22, s34, v5
    v_and_or_b32 v190, v24, s34, v5
    v_mfma_f32_16x16x32_bf16 v[112:115], v[176:179], v[204:207], v[112:115]
    ds_read_b128 v[228:231], v3 offset:37504
    v_and_or_b32 v191, v26, s34, v5
    v_mfma_f32_16x16x32_bf16 v[128:131], v[176:179], v[208:211], v[128:131]
    v_and_or_b32 v192, v81, s34, v5
    v_and_or_b32 v193, v23, s34, v5
    v_mfma_f32_16x16x32_bf16 v[144:147], v[176:179], v[212:215], v[144:147]
    ds_read_b128 v[232:235], v3 offset:55936
    v_and_or_b32 v194, v25, s34, v5
    v_mfma_f32_16x16x32_bf16 v[160:163], v[176:179], v[216:219], v[160:163]
    v_and_or_b32 v195, v27, s34, v5
    v_lshrrev_b64 v[28:29], 4, v[82:83]
    v_mfma_f32_16x16x32_bf16 v[116:119], v[180:183], v[204:207], v[116:119]
    v_lshrrev_b64 v[30:31], 8, v[82:83]
    v_lshrrev_b64 v[32:33], 12, v[82:83]
    v_mfma_f32_16x16x32_bf16 v[132:135], v[180:183], v[208:211], v[132:135]
    v_and_or_b32 v196, v82, s34, v5
    v_and_or_b32 v197, v28, s34, v5
    v_mfma_f32_16x16x32_bf16 v[148:151], v[180:183], v[212:215], v[148:151]
    v_and_or_b32 v198, v30, s34, v5
    v_and_or_b32 v199, v32, s34, v5
    v_mfma_f32_16x16x32_bf16 v[164:167], v[180:183], v[216:219], v[164:167]
    v_and_or_b32 v200, v83, s34, v5
    v_and_or_b32 v201, v29, s34, v5
    v_mfma_f32_16x16x32_bf16 v[120:123], v[184:187], v[204:207], v[120:123]
    v_and_or_b32 v202, v31, s34, v5
    v_and_or_b32 v203, v33, s34, v5
    v_mfma_f32_16x16x32_bf16 v[136:139], v[184:187], v[208:211], v[136:139]
    v_mfma_f32_16x16x32_bf16 v[152:155], v[184:187], v[212:215], v[152:155]
    v_mfma_f32_16x16x32_bf16 v[168:171], v[184:187], v[216:219], v[168:171]
    s_waitcnt vmcnt(5)
    s_waitcnt lgkmcnt(0)
    v_mfma_f32_16x16x32_bf16 v[108:111], v[188:191], v[220:223], v[108:111]
    ds_read_b128 v[204:207], v2 offset:768
    v_lshrrev_b64 v[22:23], 4, v[84:85]
    v_mfma_f32_16x16x32_bf16 v[124:127], v[188:191], v[224:227], v[124:127]
    v_lshrrev_b64 v[24:25], 8, v[84:85]
    v_lshrrev_b64 v[26:27], 12, v[84:85]
    v_mfma_f32_16x16x32_bf16 v[140:143], v[188:191], v[228:231], v[140:143]
    ds_read_b128 v[208:211], v2 offset:19200
    v_and_or_b32 v172, v84, s34, v5
    v_mfma_f32_16x16x32_bf16 v[156:159], v[188:191], v[232:235], v[156:159]
    v_and_or_b32 v173, v22, s34, v5
    v_and_or_b32 v174, v24, s34, v5
    v_mfma_f32_16x16x32_bf16 v[112:115], v[192:195], v[220:223], v[112:115]
    ds_read_b128 v[212:215], v2 offset:37632
    v_and_or_b32 v175, v26, s34, v5
    v_mfma_f32_16x16x32_bf16 v[128:131], v[192:195], v[224:227], v[128:131]
    v_and_or_b32 v176, v85, s34, v5
    v_and_or_b32 v177, v23, s34, v5
    v_mfma_f32_16x16x32_bf16 v[144:147], v[192:195], v[228:231], v[144:147]
    ds_read_b128 v[216:219], v2 offset:56064
    v_and_or_b32 v178, v25, s34, v5
    v_mfma_f32_16x16x32_bf16 v[160:163], v[192:195], v[232:235], v[160:163]
    v_and_or_b32 v179, v27, s34, v5
    v_lshrrev_b64 v[28:29], 4, v[86:87]
    v_mfma_f32_16x16x32_bf16 v[116:119], v[196:199], v[220:223], v[116:119]
    v_lshrrev_b64 v[30:31], 8, v[86:87]
    v_lshrrev_b64 v[32:33], 12, v[86:87]
    v_mfma_f32_16x16x32_bf16 v[132:135], v[196:199], v[224:227], v[132:135]
    v_and_or_b32 v180, v86, s34, v5
    v_and_or_b32 v181, v28, s34, v5
    v_mfma_f32_16x16x32_bf16 v[148:151], v[196:199], v[228:231], v[148:151]
    v_and_or_b32 v182, v30, s34, v5
    v_and_or_b32 v183, v32, s34, v5
    v_mfma_f32_16x16x32_bf16 v[164:167], v[196:199], v[232:235], v[164:167]
    v_and_or_b32 v184, v87, s34, v5
    v_and_or_b32 v185, v29, s34, v5
    v_mfma_f32_16x16x32_bf16 v[120:123], v[200:203], v[220:223], v[120:123]
    v_and_or_b32 v186, v31, s34, v5
    v_and_or_b32 v187, v33, s34, v5
    v_mfma_f32_16x16x32_bf16 v[136:139], v[200:203], v[224:227], v[136:139]
    v_mfma_f32_16x16x32_bf16 v[152:155], v[200:203], v[228:231], v[152:155]
    v_mfma_f32_16x16x32_bf16 v[168:171], v[200:203], v[232:235], v[168:171]
    s_waitcnt vmcnt(4)
    s_waitcnt lgkmcnt(0)
    v_mfma_f32_16x16x32_bf16 v[108:111], v[172:175], v[204:207], v[108:111]
    ds_read_b128 v[220:223], v3 offset:768
    v_lshrrev_b64 v[22:23], 4, v[88:89]
    v_mfma_f32_16x16x32_bf16 v[124:127], v[172:175], v[208:211], v[124:127]
    v_lshrrev_b64 v[24:25], 8, v[88:89]
    v_lshrrev_b64 v[26:27], 12, v[88:89]
    v_mfma_f32_16x16x32_bf16 v[140:143], v[172:175], v[212:215], v[140:143]
    ds_read_b128 v[224:227], v3 offset:19200
    v_and_or_b32 v188, v88, s34, v5
    v_mfma_f32_16x16x32_bf16 v[156:159], v[172:175], v[216:219], v[156:159]
    v_and_or_b32 v189, v22, s34, v5
    v_and_or_b32 v190, v24, s34, v5
    v_mfma_f32_16x16x32_bf16 v[112:115], v[176:179], v[204:207], v[112:115]
    ds_read_b128 v[228:231], v3 offset:37632
    v_and_or_b32 v191, v26, s34, v5
    v_mfma_f32_16x16x32_bf16 v[128:131], v[176:179], v[208:211], v[128:131]
    v_and_or_b32 v192, v89, s34, v5
    v_and_or_b32 v193, v23, s34, v5
    v_mfma_f32_16x16x32_bf16 v[144:147], v[176:179], v[212:215], v[144:147]
    ds_read_b128 v[232:235], v3 offset:56064
    v_and_or_b32 v194, v25, s34, v5
    v_mfma_f32_16x16x32_bf16 v[160:163], v[176:179], v[216:219], v[160:163]
    v_and_or_b32 v195, v27, s34, v5
    v_lshrrev_b64 v[28:29], 4, v[90:91]
    v_mfma_f32_16x16x32_bf16 v[116:119], v[180:183], v[204:207], v[116:119]
    v_lshrrev_b64 v[30:31], 8, v[90:91]
    v_lshrrev_b64 v[32:33], 12, v[90:91]
    v_mfma_f32_16x16x32_bf16 v[132:135], v[180:183], v[208:211], v[132:135]
    v_and_or_b32 v196, v90, s34, v5
    v_and_or_b32 v197, v28, s34, v5
    v_mfma_f32_16x16x32_bf16 v[148:151], v[180:183], v[212:215], v[148:151]
    v_and_or_b32 v198, v30, s34, v5
    v_and_or_b32 v199, v32, s34, v5
    v_mfma_f32_16x16x32_bf16 v[164:167], v[180:183], v[216:219], v[164:167]
    v_and_or_b32 v200, v91, s34, v5
    v_and_or_b32 v201, v29, s34, v5
    v_mfma_f32_16x16x32_bf16 v[120:123], v[184:187], v[204:207], v[120:123]
    v_and_or_b32 v202, v31, s34, v5
    v_and_or_b32 v203, v33, s34, v5
    v_mfma_f32_16x16x32_bf16 v[136:139], v[184:187], v[208:211], v[136:139]
    v_mfma_f32_16x16x32_bf16 v[152:155], v[184:187], v[212:215], v[152:155]
    v_mfma_f32_16x16x32_bf16 v[168:171], v[184:187], v[216:219], v[168:171]
    s_waitcnt vmcnt(3)
    s_waitcnt lgkmcnt(0)
    v_mfma_f32_16x16x32_bf16 v[108:111], v[188:191], v[220:223], v[108:111]
    ds_read_b128 v[204:207], v2 offset:896
    v_lshrrev_b64 v[22:23], 4, v[92:93]
    v_mfma_f32_16x16x32_bf16 v[124:127], v[188:191], v[224:227], v[124:127]
    v_lshrrev_b64 v[24:25], 8, v[92:93]
    v_lshrrev_b64 v[26:27], 12, v[92:93]
    v_mfma_f32_16x16x32_bf16 v[140:143], v[188:191], v[228:231], v[140:143]
    ds_read_b128 v[208:211], v2 offset:19328
    v_and_or_b32 v172, v92, s34, v5
    v_mfma_f32_16x16x32_bf16 v[156:159], v[188:191], v[232:235], v[156:159]
    v_and_or_b32 v173, v22, s34, v5
    v_and_or_b32 v174, v24, s34, v5
    v_mfma_f32_16x16x32_bf16 v[112:115], v[192:195], v[220:223], v[112:115]
    ds_read_b128 v[212:215], v2 offset:37760
    v_and_or_b32 v175, v26, s34, v5
    v_mfma_f32_16x16x32_bf16 v[128:131], v[192:195], v[224:227], v[128:131]
    v_and_or_b32 v176, v93, s34, v5
    v_and_or_b32 v177, v23, s34, v5
    v_mfma_f32_16x16x32_bf16 v[144:147], v[192:195], v[228:231], v[144:147]
    ds_read_b128 v[216:219], v2 offset:56192
    v_and_or_b32 v178, v25, s34, v5
    v_mfma_f32_16x16x32_bf16 v[160:163], v[192:195], v[232:235], v[160:163]
    v_and_or_b32 v179, v27, s34, v5
    v_lshrrev_b64 v[28:29], 4, v[94:95]
    v_mfma_f32_16x16x32_bf16 v[116:119], v[196:199], v[220:223], v[116:119]
    v_lshrrev_b64 v[30:31], 8, v[94:95]
    v_lshrrev_b64 v[32:33], 12, v[94:95]
    v_mfma_f32_16x16x32_bf16 v[132:135], v[196:199], v[224:227], v[132:135]
    v_and_or_b32 v180, v94, s34, v5
    v_and_or_b32 v181, v28, s34, v5
    v_mfma_f32_16x16x32_bf16 v[148:151], v[196:199], v[228:231], v[148:151]
    v_and_or_b32 v182, v30, s34, v5
    v_and_or_b32 v183, v32, s34, v5
    v_mfma_f32_16x16x32_bf16 v[164:167], v[196:199], v[232:235], v[164:167]
    v_and_or_b32 v184, v95, s34, v5
    v_and_or_b32 v185, v29, s34, v5
    v_mfma_f32_16x16x32_bf16 v[120:123], v[200:203], v[220:223], v[120:123]
    v_and_or_b32 v186, v31, s34, v5
    v_and_or_b32 v187, v33, s34, v5
    v_mfma_f32_16x16x32_bf16 v[136:139], v[200:203], v[224:227], v[136:139]
    v_mfma_f32_16x16x32_bf16 v[152:155], v[200:203], v[228:231], v[152:155]
    v_mfma_f32_16x16x32_bf16 v[168:171], v[200:203], v[232:235], v[168:171]
    s_waitcnt vmcnt(2)
    s_waitcnt lgkmcnt(0)
    v_mfma_f32_16x16x32_bf16 v[108:111], v[172:175], v[204:207], v[108:111]
    ds_read_b128 v[220:223], v3 offset:896
    v_lshrrev_b64 v[22:23], 4, v[96:97]
    v_mfma_f32_16x16x32_bf16 v[124:127], v[172:175], v[208:211], v[124:127]
    v_lshrrev_b64 v[24:25], 8, v[96:97]
    v_lshrrev_b64 v[26:27], 12, v[96:97]
    v_mfma_f32_16x16x32_bf16 v[140:143], v[172:175], v[212:215], v[140:143]
    ds_read_b128 v[224:227], v3 offset:19328
    v_and_or_b32 v188, v96, s34, v5
    v_mfma_f32_16x16x32_bf16 v[156:159], v[172:175], v[216:219], v[156:159]
    v_and_or_b32 v189, v22, s34, v5
    v_and_or_b32 v190, v24, s34, v5
    v_mfma_f32_16x16x32_bf16 v[112:115], v[176:179], v[204:207], v[112:115]
    ds_read_b128 v[228:231], v3 offset:37760
    v_and_or_b32 v191, v26, s34, v5
    v_mfma_f32_16x16x32_bf16 v[128:131], v[176:179], v[208:211], v[128:131]
    v_and_or_b32 v192, v97, s34, v5
    v_and_or_b32 v193, v23, s34, v5
    v_mfma_f32_16x16x32_bf16 v[144:147], v[176:179], v[212:215], v[144:147]
    ds_read_b128 v[232:235], v3 offset:56192
    v_and_or_b32 v194, v25, s34, v5
    v_mfma_f32_16x16x32_bf16 v[160:163], v[176:179], v[216:219], v[160:163]
    v_and_or_b32 v195, v27, s34, v5
    v_lshrrev_b64 v[28:29], 4, v[98:99]
    v_mfma_f32_16x16x32_bf16 v[116:119], v[180:183], v[204:207], v[116:119]
    v_lshrrev_b64 v[30:31], 8, v[98:99]
    v_lshrrev_b64 v[32:33], 12, v[98:99]
    v_mfma_f32_16x16x32_bf16 v[132:135], v[180:183], v[208:211], v[132:135]
    v_and_or_b32 v196, v98, s34, v5
    v_and_or_b32 v197, v28, s34, v5
    v_mfma_f32_16x16x32_bf16 v[148:151], v[180:183], v[212:215], v[148:151]
    v_and_or_b32 v198, v30, s34, v5
    v_and_or_b32 v199, v32, s34, v5
    v_mfma_f32_16x16x32_bf16 v[164:167], v[180:183], v[216:219], v[164:167]
    v_and_or_b32 v200, v99, s34, v5
    v_and_or_b32 v201, v29, s34, v5
    v_mfma_f32_16x16x32_bf16 v[120:123], v[184:187], v[204:207], v[120:123]
    v_and_or_b32 v202, v31, s34, v5
    v_and_or_b32 v203, v33, s34, v5
    v_mfma_f32_16x16x32_bf16 v[136:139], v[184:187], v[208:211], v[136:139]
    v_mfma_f32_16x16x32_bf16 v[152:155], v[184:187], v[212:215], v[152:155]
    v_mfma_f32_16x16x32_bf16 v[168:171], v[184:187], v[216:219], v[168:171]
    s_waitcnt vmcnt(1)
    s_waitcnt lgkmcnt(0)
    v_mfma_f32_16x16x32_bf16 v[108:111], v[188:191], v[220:223], v[108:111]
    ds_read_b128 v[204:207], v2 offset:1024
    v_lshrrev_b64 v[22:23], 4, v[100:101]
    v_mfma_f32_16x16x32_bf16 v[124:127], v[188:191], v[224:227], v[124:127]
    v_lshrrev_b64 v[24:25], 8, v[100:101]
    v_lshrrev_b64 v[26:27], 12, v[100:101]
    v_mfma_f32_16x16x32_bf16 v[140:143], v[188:191], v[228:231], v[140:143]
    ds_read_b128 v[208:211], v2 offset:19456
    v_and_or_b32 v172, v100, s34, v5
    v_mfma_f32_16x16x32_bf16 v[156:159], v[188:191], v[232:235], v[156:159]
    v_and_or_b32 v173, v22, s34, v5
    v_and_or_b32 v174, v24, s34, v5
    v_mfma_f32_16x16x32_bf16 v[112:115], v[192:195], v[220:223], v[112:115]
    ds_read_b128 v[212:215], v2 offset:37888
    v_and_or_b32 v175, v26, s34, v5
    v_mfma_f32_16x16x32_bf16 v[128:131], v[192:195], v[224:227], v[128:131]
    v_and_or_b32 v176, v101, s34, v5
    v_and_or_b32 v177, v23, s34, v5
    v_mfma_f32_16x16x32_bf16 v[144:147], v[192:195], v[228:231], v[144:147]
    ds_read_b128 v[216:219], v2 offset:56320
    v_and_or_b32 v178, v25, s34, v5
    v_mfma_f32_16x16x32_bf16 v[160:163], v[192:195], v[232:235], v[160:163]
    v_and_or_b32 v179, v27, s34, v5
    v_lshrrev_b64 v[28:29], 4, v[102:103]
    v_mfma_f32_16x16x32_bf16 v[116:119], v[196:199], v[220:223], v[116:119]
    v_lshrrev_b64 v[30:31], 8, v[102:103]
    v_lshrrev_b64 v[32:33], 12, v[102:103]
    v_mfma_f32_16x16x32_bf16 v[132:135], v[196:199], v[224:227], v[132:135]
    v_and_or_b32 v180, v102, s34, v5
    v_and_or_b32 v181, v28, s34, v5
    v_mfma_f32_16x16x32_bf16 v[148:151], v[196:199], v[228:231], v[148:151]
    v_and_or_b32 v182, v30, s34, v5
    v_and_or_b32 v183, v32, s34, v5
    v_mfma_f32_16x16x32_bf16 v[164:167], v[196:199], v[232:235], v[164:167]
    v_and_or_b32 v184, v103, s34, v5
    v_and_or_b32 v185, v29, s34, v5
    v_mfma_f32_16x16x32_bf16 v[120:123], v[200:203], v[220:223], v[120:123]
    v_and_or_b32 v186, v31, s34, v5
    v_and_or_b32 v187, v33, s34, v5
    v_mfma_f32_16x16x32_bf16 v[136:139], v[200:203], v[224:227], v[136:139]
    v_mfma_f32_16x16x32_bf16 v[152:155], v[200:203], v[228:231], v[152:155]
    v_mfma_f32_16x16x32_bf16 v[168:171], v[200:203], v[232:235], v[168:171]
    s_waitcnt vmcnt(0)
    s_waitcnt lgkmcnt(0)
    v_mfma_f32_16x16x32_bf16 v[108:111], v[172:175], v[204:207], v[108:111]
    ds_read_b128 v[220:223], v3 offset:1024
    v_lshrrev_b64 v[22:23], 4, v[104:105]
    v_mfma_f32_16x16x32_bf16 v[124:127], v[172:175], v[208:211], v[124:127]
    v_lshrrev_b64 v[24:25], 8, v[104:105]
    v_lshrrev_b64 v[26:27], 12, v[104:105]
    v_mfma_f32_16x16x32_bf16 v[140:143], v[172:175], v[212:215], v[140:143]
    ds_read_b128 v[224:227], v3 offset:19456
    v_and_or_b32 v188, v104, s34, v5
    v_mfma_f32_16x16x32_bf16 v[156:159], v[172:175], v[216:219], v[156:159]
    v_and_or_b32 v189, v22, s34, v5
    v_and_or_b32 v190, v24, s34, v5
    v_mfma_f32_16x16x32_bf16 v[112:115], v[176:179], v[204:207], v[112:115]
    ds_read_b128 v[228:231], v3 offset:37888
    v_and_or_b32 v191, v26, s34, v5
    v_mfma_f32_16x16x32_bf16 v[128:131], v[176:179], v[208:211], v[128:131]
    v_and_or_b32 v192, v105, s34, v5
    v_and_or_b32 v193, v23, s34, v5
    v_mfma_f32_16x16x32_bf16 v[144:147], v[176:179], v[212:215], v[144:147]
    ds_read_b128 v[232:235], v3 offset:56320
    v_and_or_b32 v194, v25, s34, v5
    v_mfma_f32_16x16x32_bf16 v[160:163], v[176:179], v[216:219], v[160:163]
    v_and_or_b32 v195, v27, s34, v5
    v_lshrrev_b64 v[28:29], 4, v[106:107]
    v_mfma_f32_16x16x32_bf16 v[116:119], v[180:183], v[204:207], v[116:119]
    v_lshrrev_b64 v[30:31], 8, v[106:107]
    v_lshrrev_b64 v[32:33], 12, v[106:107]
    v_mfma_f32_16x16x32_bf16 v[132:135], v[180:183], v[208:211], v[132:135]
    v_and_or_b32 v196, v106, s34, v5
    v_and_or_b32 v197, v28, s34, v5
    v_mfma_f32_16x16x32_bf16 v[148:151], v[180:183], v[212:215], v[148:151]
    v_and_or_b32 v198, v30, s34, v5
    v_and_or_b32 v199, v32, s34, v5
    v_mfma_f32_16x16x32_bf16 v[164:167], v[180:183], v[216:219], v[164:167]
    v_and_or_b32 v200, v107, s34, v5
    v_and_or_b32 v201, v29, s34, v5
    v_mfma_f32_16x16x32_bf16 v[120:123], v[184:187], v[204:207], v[120:123]
    v_and_or_b32 v202, v31, s34, v5
    v_and_or_b32 v203, v33, s34, v5
    v_mfma_f32_16x16x32_bf16 v[136:139], v[184:187], v[208:211], v[136:139]
    v_mfma_f32_16x16x32_bf16 v[152:155], v[184:187], v[212:215], v[152:155]
    v_mfma_f32_16x16x32_bf16 v[168:171], v[184:187], v[216:219], v[168:171]
    s_waitcnt lgkmcnt(0)
    s_nop 0
    v_mfma_f32_16x16x32_bf16 v[108:111], v[188:191], v[220:223], v[108:111]
    ds_read_b128 v[36:39], v14 offset:0
    v_mfma_f32_16x16x32_bf16 v[124:127], v[188:191], v[224:227], v[124:127]
    v_mfma_f32_16x16x32_bf16 v[140:143], v[188:191], v[228:231], v[140:143]
    ds_read_b128 v[40:43], v14 offset:16
    v_mfma_f32_16x16x32_bf16 v[156:159], v[188:191], v[232:235], v[156:159]
    v_mfma_f32_16x16x32_bf16 v[112:115], v[192:195], v[220:223], v[112:115]
    ds_read_b128 v[44:47], v14 offset:32
    v_mfma_f32_16x16x32_bf16 v[128:131], v[192:195], v[224:227], v[128:131]
    v_mfma_f32_16x16x32_bf16 v[144:147], v[192:195], v[228:231], v[144:147]
    ds_read_b128 v[48:51], v14 offset:48
    v_mfma_f32_16x16x32_bf16 v[160:163], v[192:195], v[232:235], v[160:163]
    v_mfma_f32_16x16x32_bf16 v[116:119], v[196:199], v[220:223], v[116:119]
    v_mfma_f32_16x16x32_bf16 v[132:135], v[196:199], v[224:227], v[132:135]
    v_mfma_f32_16x16x32_bf16 v[148:151], v[196:199], v[228:231], v[148:151]
    v_mfma_f32_16x16x32_bf16 v[164:167], v[196:199], v[232:235], v[164:167]
    v_mfma_f32_16x16x32_bf16 v[120:123], v[200:203], v[220:223], v[120:123]
    v_mfma_f32_16x16x32_bf16 v[136:139], v[200:203], v[224:227], v[136:139]
    v_mfma_f32_16x16x32_bf16 v[152:155], v[200:203], v[228:231], v[152:155]
    v_mfma_f32_16x16x32_bf16 v[168:171], v[200:203], v[232:235], v[168:171]
    s_setprio 3
    s_nop 7
    s_waitcnt lgkmcnt(0)
    v_mul_f32 v108, v108, v36
    v_mul_f32 v112, v112, v37
    v_mul_f32 v116, v116, v38
    v_mul_f32 v120, v120, v39
    v_mul_f32 v109, v109, v40
    v_mul_f32 v113, v113, v41
    v_mul_f32 v117, v117, v42
    v_mul_f32 v121, v121, v43
    v_mul_f32 v110, v110, v44
    v_mul_f32 v114, v114, v45
    v_mul_f32 v118, v118, v46
    v_mul_f32 v122, v122, v47
    v_mul_f32 v111, v111, v48
    v_mul_f32 v115, v115, v49
    v_mul_f32 v119, v119, v50
    v_mul_f32 v123, v123, v51
    v_cvt_pk_bf16_f32 v236, v108, v112
    v_cvt_pk_bf16_f32 v237, v116, v120
    v_cvt_pk_bf16_f32 v238, v109, v113
    v_cvt_pk_bf16_f32 v239, v117, v121
    v_cvt_pk_bf16_f32 v240, v110, v114
    v_cvt_pk_bf16_f32 v241, v118, v122
    v_cvt_pk_bf16_f32 v242, v111, v115
    v_cvt_pk_bf16_f32 v243, v119, v123
    ds_write_b128 v10, v[236:239] offset:0
    ds_write_b128 v11, v[240:243] offset:0
    ds_read_b128 v[204:207], v12 offset:0
    ds_read_b128 v[208:211], v12 offset:1024
    v_mul_f32 v124, v124, v36
    v_mul_f32 v128, v128, v37
    v_mul_f32 v132, v132, v38
    v_mul_f32 v136, v136, v39
    v_mul_f32 v125, v125, v40
    v_mul_f32 v129, v129, v41
    v_mul_f32 v133, v133, v42
    v_mul_f32 v137, v137, v43
    v_mul_f32 v126, v126, v44
    v_mul_f32 v130, v130, v45
    v_mul_f32 v134, v134, v46
    v_mul_f32 v138, v138, v47
    v_mul_f32 v127, v127, v48
    v_mul_f32 v131, v131, v49
    v_mul_f32 v135, v135, v50
    v_mul_f32 v139, v139, v51
    v_cvt_pk_bf16_f32 v244, v124, v128
    v_cvt_pk_bf16_f32 v245, v132, v136
    v_cvt_pk_bf16_f32 v246, v125, v129
    v_cvt_pk_bf16_f32 v247, v133, v137
    v_cvt_pk_bf16_f32 v248, v126, v130
    v_cvt_pk_bf16_f32 v249, v134, v138
    v_cvt_pk_bf16_f32 v250, v127, v131
    v_cvt_pk_bf16_f32 v251, v135, v139
    ds_write_b128 v10, v[244:247] offset:2048
    ds_write_b128 v11, v[248:251] offset:2048
    ds_read_b128 v[212:215], v12 offset:2048
    ds_read_b128 v[216:219], v12 offset:3072
    s_waitcnt lgkmcnt(4)
    buffer_store_dwordx4 v[204:207], v13, s[24:27], s52 offen sc1 nt
    buffer_store_dwordx4 v[208:211], v13, s[24:27], s53 offen sc1 nt
    v_mul_f32 v140, v140, v36
    v_mul_f32 v144, v144, v37
    v_mul_f32 v148, v148, v38
    v_mul_f32 v152, v152, v39
    v_mul_f32 v141, v141, v40
    v_mul_f32 v145, v145, v41
    v_mul_f32 v149, v149, v42
    v_mul_f32 v153, v153, v43
    v_mul_f32 v142, v142, v44
    v_mul_f32 v146, v146, v45
    v_mul_f32 v150, v150, v46
    v_mul_f32 v154, v154, v47
    v_mul_f32 v143, v143, v48
    v_mul_f32 v147, v147, v49
    v_mul_f32 v151, v151, v50
    v_mul_f32 v155, v155, v51
    v_cvt_pk_bf16_f32 v236, v140, v144
    v_cvt_pk_bf16_f32 v237, v148, v152
    v_cvt_pk_bf16_f32 v238, v141, v145
    v_cvt_pk_bf16_f32 v239, v149, v153
    v_cvt_pk_bf16_f32 v240, v142, v146
    v_cvt_pk_bf16_f32 v241, v150, v154
    v_cvt_pk_bf16_f32 v242, v143, v147
    v_cvt_pk_bf16_f32 v243, v151, v155
    ds_write_b128 v10, v[236:239] offset:0
    ds_write_b128 v11, v[240:243] offset:0
    ds_read_b128 v[220:223], v12 offset:0
    ds_read_b128 v[224:227], v12 offset:1024
    s_waitcnt lgkmcnt(4)
    buffer_store_dwordx4 v[212:215], v13, s[24:27], s54 offen sc1 nt
    buffer_store_dwordx4 v[216:219], v13, s[24:27], s55 offen sc1 nt
    v_mul_f32 v156, v156, v36
    v_mul_f32 v160, v160, v37
    v_mul_f32 v164, v164, v38
    v_mul_f32 v168, v168, v39
    v_mul_f32 v157, v157, v40
    v_mul_f32 v161, v161, v41
    v_mul_f32 v165, v165, v42
    v_mul_f32 v169, v169, v43
    v_mul_f32 v158, v158, v44
    v_mul_f32 v162, v162, v45
    v_mul_f32 v166, v166, v46
    v_mul_f32 v170, v170, v47
    v_mul_f32 v159, v159, v48
    v_mul_f32 v163, v163, v49
    v_mul_f32 v167, v167, v50
    v_mul_f32 v171, v171, v51
    v_cvt_pk_bf16_f32 v244, v156, v160
    v_cvt_pk_bf16_f32 v245, v164, v168
    v_cvt_pk_bf16_f32 v246, v157, v161
    v_cvt_pk_bf16_f32 v247, v165, v169
    v_cvt_pk_bf16_f32 v248, v158, v162
    v_cvt_pk_bf16_f32 v249, v166, v170
    v_cvt_pk_bf16_f32 v250, v159, v163
    v_cvt_pk_bf16_f32 v251, v167, v171
    ds_write_b128 v10, v[244:247] offset:2048
    ds_write_b128 v11, v[248:251] offset:2048
    ds_read_b128 v[228:231], v12 offset:2048
    ds_read_b128 v[232:235], v12 offset:3072
    s_waitcnt lgkmcnt(4)
    buffer_store_dwordx4 v[220:223], v13, s[24:27], s56 offen sc1 nt
    buffer_store_dwordx4 v[224:227], v13, s[24:27], s57 offen sc1 nt
    s_waitcnt lgkmcnt(1)
    buffer_store_dwordx4 v[228:231], v13, s[24:27], s58 offen sc1 nt
    s_waitcnt lgkmcnt(0)
    buffer_store_dwordx4 v[232:235], v13, s[24:27], s59 offen sc1 nt
L_fin:
L_done:
    s_endpgm
    s_endpgm
    s_endpgm
    s_endpgm
    s_endpgm
    s_endpgm
    s_endpgm
    s_endpgm
    s_endpgm
    s_endpgm
    s_endpgm
    s_endpgm
    s_endpgm
    s_endpgm
    s_endpgm
    s_endpgm
    s_endpgm
    s_endpgm
    s_endpgm
    s_endpgm
    s_endpgm
    s_endpgm
    s_endpgm
    s_endpgm
    s_endpgm
    s_endpgm
    s_endpgm
    s_endpgm
    s_endpgm
    s_endpgm
    s_endpgm
    s_endpgm
    s_endpgm
    s_endpgm
    s_endpgm
    s_endpgm
    s_endpgm
    s_endpgm
    s_endpgm
    s_endpgm
    s_endpgm
    s_endpgm
    s_endpgm
    s_endpgm
    s_endpgm
    s_endpgm
    s_endpgm
    s_endpgm
    s_endpgm
    s_endpgm
    s_endpgm
    s_endpgm
    s_endpgm
    s_endpgm
    s_endpgm
    s_endpgm
    s_endpgm
    s_endpgm
    s_endpgm
    s_endpgm
    s_endpgm
    s_endpgm
    s_endpgm
    s_endpgm
    s_endpgm
    s_endpgm
    s_endpgm
    s_endpgm
    s_endpgm
    s_endpgm
    s_endpgm
    s_endpgm
    s_endpgm
    s_endpgm
    s_endpgm
    s_endpgm
    s_endpgm
    s_endpgm
    s_endpgm
    s_endpgm
    s_endpgm
    s_endpgm
    s_endpgm
    s_endpgm
    s_endpgm
    s_endpgm
    s_endpgm
    s_endpgm
    s_endpgm
    s_endpgm
    s_endpgm
    s_endpgm
    s_endpgm
    s_endpgm
    s_endpgm
    s_endpgm
    s_endpgm
    s_endpgm
    s_endpgm
    s_endpgm
    s_endpgm
    s_endpgm
    s_endpgm
    s_endpgm
    s_endpgm
    s_endpgm
    s_endpgm
    s_endpgm
    s_endpgm
    s_endpgm
    s_endpgm
    s_endpgm
    s_endpgm
    s_endpgm
    s_endpgm
    s_endpgm
    s_endpgm
    s_endpgm
    s_endpgm
    s_endpgm
    s_endpgm
    s_endpgm
    s_endpgm
    s_endpgm
    s_endpgm
    s_endpgm
    s_endpgm
    s_endpgm
    s_endpgm
    s_endpgm
    s_endpgm
    s_endpgm
    s_endpgm
    s_endpgm
    s_endpgm
    s_endpgm
    s_endpgm
    s_endpgm
    s_endpgm
    s_endpgm
    s_endpgm
    s_endpgm
    s_endpgm
    s_endpgm
    s_endpgm
    s_endpgm
    s_endpgm
    s_endpgm
    s_endpgm
    s_endpgm
    s_endpgm
    s_endpgm
    s_endpgm
    s_endpgm
    s_endpgm
    s_endpgm
    s_endpgm
    s_endpgm
    s_endpgm
    s_endpgm
    s_endpgm
    s_endpgm
    s_endpgm
    s_endpgm
    s_endpgm
    s_endpgm
    s_endpgm
    s_endpgm
    s_endpgm
    s_endpgm
    s_endpgm
    s_endpgm
    s_endpgm
    s_endpgm
    s_endpgm
    s_endpgm
    s_endpgm
    s_endpgm
    s_endpgm
    s_endpgm
    s_endpgm
    s_endpgm
    s_endpgm
    s_endpgm
    s_endpgm
    s_endpgm
    s_endpgm
    s_endpgm
    s_endpgm
    s_endpgm
    s_endpgm
    s_endpgm
    s_endpgm
    s_endpgm
    s_endpgm
    s_endpgm
    s_endpgm
    s_endpgm
    s_endpgm
    s_endpgm
    s_endpgm
    s_endpgm
    s_endpgm
    s_endpgm
    s_endpgm
    s_endpgm
    s_endpgm
    s_endpgm
    s_endpgm
    s_endpgm
    s_endpgm
    s_endpgm
    s_endpgm
    s_endpgm
    s_endpgm
    s_endpgm
    s_endpgm
    s_endpgm
    s_endpgm
    s_endpgm
    s_endpgm
    s_endpgm
    s_endpgm
    s_endpgm
    s_endpgm
    s_endpgm
    s_endpgm
    s_endpgm
    s_endpgm
    s_endpgm
    s_endpgm
    s_endpgm
    s_endpgm
    s_endpgm
    s_endpgm
    s_endpgm
    s_endpgm
    s_endpgm
    s_endpgm
    s_endpgm
    s_endpgm
    s_endpgm
    s_endpgm
    s_endpgm
    s_endpgm
    s_endpgm
    s_endpgm
    s_endpgm
    s_endpgm
    s_endpgm
    s_endpgm
    s_endpgm
    s_endpgm
    s_endpgm
    s_endpgm
    s_endpgm
    s_endpgm
    s_endpgm
    s_endpgm
    s_endpgm
    s_endpgm
    s_endpgm
    s_endpgm
    s_endpgm
    s_endpgm
    s_endpgm
    s_endpgm
    s_endpgm
    s_endpgm
    s_endpgm
    s_endpgm
    s_endpgm
    s_endpgm
    s_endpgm
    s_endpgm
    s_endpgm
    s_endpgm
    s_endpgm
    s_endpgm
    s_endpgm
    s_endpgm
    s_endpgm
    s_endpgm
    s_endpgm
    s_endpgm
    s_endpgm
    s_endpgm
    s_endpgm
    s_endpgm
    s_endpgm
    s_endpgm
    s_endpgm
    s_endpgm
    s_endpgm
    s_endpgm
    s_endpgm
    s_endpgm
    s_endpgm
    s_endpgm
    s_endpgm
    s_endpgm
    s_endpgm
    s_endpgm
    s_endpgm
    s_endpgm
    s_endpgm
    s_endpgm
    s_endpgm
    s_endpgm
    s_endpgm
    s_endpgm
    s_endpgm
    s_endpgm
    s_endpgm
    s_endpgm
    s_endpgm
    s_endpgm
    s_endpgm
    s_endpgm
    s_endpgm
    s_endpgm
    s_endpgm
    s_endpgm
    s_endpgm
    s_endpgm
    s_endpgm
    s_endpgm
    s_endpgm
    s_endpgm
    s_endpgm
    s_endpgm
    s_endpgm
    s_endpgm
    s_endpgm
    s_endpgm
    s_endpgm
    s_endpgm
    s_endpgm
    s_endpgm
    s_endpgm
    s_endpgm
    s_endpgm
    s_endpgm
    s_endpgm
    s_endpgm
    s_endpgm
    s_endpgm
    s_endpgm
    s_endpgm
    s_endpgm
    s_endpgm
    s_endpgm
    s_endpgm
    s_endpgm
    s_endpgm
    s_endpgm
    s_endpgm
    s_endpgm
    s_endpgm
    s_endpgm
    s_endpgm
    s_endpgm
    s_endpgm
    s_endpgm
    s_endpgm
    s_endpgm
    s_endpgm
    s_endpgm
    s_endpgm
    s_endpgm
    s_endpgm
    s_endpgm
    s_endpgm
    s_endpgm
    s_endpgm
    s_endpgm
    s_endpgm
    s_endpgm
    s_endpgm
    s_endpgm
    s_endpgm
    s_endpgm
    s_endpgm
    s_endpgm
    s_endpgm
    s_endpgm
    s_endpgm
    s_endpgm
    s_endpgm
    s_endpgm
    s_endpgm
    s_endpgm
    s_endpgm
    s_endpgm
    s_endpgm
    s_endpgm
    s_endpgm
    s_endpgm
    s_endpgm
    s_endpgm
    s_endpgm
    s_endpgm
    s_endpgm
    s_endpgm
    s_endpgm
    s_endpgm
    s_endpgm
    s_endpgm
    s_endpgm
    s_endpgm
    s_endpgm
    s_endpgm
    s_endpgm
    s_endpgm
    s_endpgm
    s_endpgm
    s_endpgm
    s_endpgm
    s_endpgm
    s_endpgm
    s_endpgm
    s_endpgm
    s_endpgm
    s_endpgm
    s_endpgm
    s_endpgm
    s_endpgm
    s_endpgm
    s_endpgm
    s_endpgm
    s_endpgm
    s_endpgm
    s_endpgm
    s_endpgm
    s_endpgm
    s_endpgm
    s_endpgm
    s_endpgm
    s_endpgm
    s_endpgm
    s_endpgm
    s_endpgm
    s_endpgm
    s_endpgm
    s_endpgm
    s_endpgm
    s_endpgm
    s_endpgm
    s_endpgm
    s_endpgm
    s_endpgm
    s_endpgm
    s_endpgm
    s_endpgm
    s_endpgm
    s_endpgm
    s_endpgm
    s_endpgm
    s_endpgm
    s_endpgm
    s_endpgm
    s_endpgm
    s_endpgm
    s_endpgm
    s_endpgm
    s_endpgm
    s_endpgm
    s_endpgm
    s_endpgm
    s_endpgm
    s_endpgm
    s_endpgm
    s_endpgm
    s_endpgm
    s_endpgm
    s_endpgm
    s_endpgm
    s_endpgm
    s_endpgm
    s_endpgm
    s_endpgm
    s_endpgm
    s_endpgm
    s_endpgm
    s_endpgm
    s_endpgm
    s_endpgm
    s_endpgm
    s_endpgm
    s_endpgm
    s_endpgm
    s_endpgm
    s_endpgm
    s_endpgm
    s_endpgm
    s_endpgm
    s_endpgm
    s_endpgm
    s_endpgm
    s_endpgm
    s_endpgm
    s_endpgm
    s_endpgm
    s_endpgm
    s_endpgm
    s_endpgm
    s_endpgm
    s_endpgm
    s_endpgm
    s_endpgm
    s_endpgm
    s_endpgm
    s_endpgm
L_end:
.section .rodata,"a"
.p2align 6
.amdhsa_kernel standalone__weight_only_int_gptq__prompt_kernel
  .amdhsa_next_free_vgpr 252
  .amdhsa_next_free_sgpr 102
  .amdhsa_accum_offset 252
  .amdhsa_group_segment_fixed_size 0
  .amdhsa_kernarg_size 64
  .amdhsa_user_sgpr_count 2
  .amdhsa_user_sgpr_kernarg_segment_ptr 1
  .amdhsa_system_sgpr_workgroup_id_x 1
.end_amdhsa_kernel
```
